```python
import torch

def _softmax(x, axis=-1):
    return torch.softmax(x, dim=axis)

def _gelu(x):
    return torch.nn.functional.gelu(x, approximate='tanh')

def _silu(x):
    return torch.nn.functional.silu(x)

def _sigmoid(x):
    return torch.sigmoid(x)

def _layernorm(x, axis=-1, eps=1e-05):
    m = x.mean(dim=axis, keepdim=True)
    v = x.var(dim=axis, keepdim=True, unbiased=False)
    return (x - m) / torch.sqrt(v + eps)

def _scatter_add(tgt, idx, src, axis=0):
    return tgt.clone().index_add_(axis, idx, src)

def _segment_sum(src, seg, n):
    out = torch.zeros((n,) + src.shape[1:], dtype=src.dtype)
    return out.index_add_(0, seg, src)

def _pad(x, pw):
    flat = tuple((v for pair in reversed(pw) for v in pair))
    return torch.nn.functional.pad(x, flat)
kernel_name = 'adaLN_cond__linear_kernel_hedgehog__glu_gated_reglu__prompt'

def setup_inputs():

    _w = lambda a: (lambda t: t.to(torch.bfloat16) if t.is_floating_point() else t)(torch.as_tensor(a))

    def _A_setup():
        B, S, D, H = (1, 2048, 512, 32)
        Dh = D // H
        return {'x': _w((lambda *s: torch.randn(*s, dtype=torch.bfloat16) * 0.05)(B, S, D)), 'wqkv': _w((lambda *s: torch.randn(*s, dtype=torch.bfloat16) * 0.4)(D, 3 * D)), 'w_phi': _w((lambda *s: torch.randn(*s, dtype=torch.bfloat16) * 0.4)(H, Dh, Dh) * Dh ** (-0.5)), 'wo': _w((lambda *s: torch.randn(*s, dtype=torch.bfloat16) * 0.05)(D, D))}
    _A_in = _A_setup()

    def _B_setup():
        B, S, D, F = (1, 2048, 512, 1376)
        return {'x': _w((lambda *s: torch.randn(*s, dtype=torch.bfloat16) * 0.05)(B, S, D)), 'W_gate': _w((lambda *s: torch.randn(*s, dtype=torch.bfloat16) * 0.8)(D, F) * (2.0 / D) ** 0.5), 'W_up': _w((lambda *s: torch.randn(*s, dtype=torch.bfloat16) * 0.8)(D, F) * (2.0 / D) ** 0.5), 'W_down': _w((lambda *s: torch.randn(*s, dtype=torch.bfloat16) * 0.8)(F, D) * (1.0 / F) ** 0.5)}
    _B_in = _B_setup()
    return {'A_x': _A_in['x'], 'A_wqkv': _A_in['wqkv'], 'A_w_phi': _A_in['w_phi'], 'A_wo': _A_in['wo'], 'B_x': _B_in['x'], 'B_W_gate': _B_in['W_gate'], 'B_W_up': _B_in['W_up'], 'B_W_down': _B_in['W_down'], 'c': _w((lambda *s: torch.randn(*s, dtype=torch.bfloat16) * 0.2)(1, 512) * 8.0), 'w_mod': _w((lambda *s: torch.randn(*s, dtype=torch.bfloat16) * 0.2)(512, 6 * 512) * 512 ** (-0.5) * 8.0)}

def reference(A_x, A_wqkv, A_w_phi, A_wo, B_x, B_W_gate, B_W_up, B_W_down, c, w_mod):

    def _A_ref(x, wqkv, w_phi, wo):
        B, S, D = x.shape
        H = 32
        Dh = D // H
        qkv = (lambda x, *d: x.permute(*d))((x @ wqkv).reshape(B, S, 3, H, Dh), 2, 0, 3, 1, 4)
        q, k, v = (qkv[0], qkv[1], qkv[2])
        pq = torch.einsum('bhsd,hdf->bhsf', q, w_phi)
        pk = torch.einsum('bhsd,hdf->bhsf', k, w_phi)
        phi_q = torch.concatenate([_softmax(pq, axis=-1), _softmax(-pq, axis=-1)], axis=-1)
        phi_k = torch.concatenate([_softmax(pk, axis=-1), _softmax(-pk, axis=-1)], axis=-1)
        kv = torch.einsum('bhsf,bhsd->bhfd', phi_k, v)
        z = torch.einsum('bhsf->bhf', phi_k)
        num = torch.einsum('bhqf,bhfd->bhqd', phi_q, kv)
        den = torch.einsum('bhqf,bhf->bhq', phi_q, z)[..., None] + 1e-06
        o = num / den
        return (lambda x, *d: x.permute(*d))(o, 0, 2, 1, 3).reshape(B, S, D) @ wo

    def _B_ref(x, W_gate, W_up, W_down):
        gate = torch.einsum('bsd,df->bsf', x, W_gate)
        up = torch.einsum('bsd,df->bsf', x, W_up)
        gate = gate * (lambda x, dt: x.to(dt))(gate > 0, gate.dtype)
        h = gate * up
        return torch.einsum('bsf,fd->bsd', h, W_down)
    x = A_x
    mod = (_silu(c) @ w_mod).reshape(c.shape[0], 6, 1, -1)
    sa, ca, ga, sb, cb, gb = (mod[:, 0].clone(), mod[:, 1].clone(), mod[:, 2].clone(), mod[:, 3].clone(), mod[:, 4].clone(), mod[:, 5].clone())
    h = _layernorm(x, axis=-1) * (1 + ca) + sa
    x = x + ga * _A_ref(h, A_wqkv, A_w_phi, A_wo)
    h = _layernorm(x, axis=-1) * (1 + cb) + sb
    x = x + gb * _B_ref(h, B_W_gate, B_W_up, B_W_down)
    return x
```

```asm
; @launch grid=(256,1,1) block=(512,1,1) lds=163840
.amdgcn_target "amdgcn-amd-amdhsa--gfx950"
.text
.globl adaLN_cond__linear_kernel_hedgehog__glu_gated_reglu__prompt_kernel
.p2align 8
.type adaLN_cond__linear_kernel_hedgehog__glu_gated_reglu__prompt_kernel,@function
adaLN_cond__linear_kernel_hedgehog__glu_gated_reglu__prompt_kernel:
    s_cmp_ge_u32 s2, 256
    s_cbranch_scc1 L_end
    s_load_dwordx2 s[12:13], s[0:1], 96
    s_load_dwordx2 s[20:21], s[0:1], 64
    s_load_dwordx2 s[16:17], s[0:1], 72
    s_load_dwordx2 s[4:5], s[0:1], 0
    s_load_dwordx2 s[8:9], s[0:1], 8
    s_load_dwordx2 s[24:25], s[0:1], 16
    v_lshrrev_b32 v2, 6, v0
    v_and_b32 v0, 63, v0
    v_readfirstlane_b32 s52, v2
    s_and_b32 s54, s2, 7
    s_lshr_b32 s59, s2, 7
    s_lshl1_add_u32 s54, s54, s59
    s_bfe_u32 s55, s2, 0x40003
    s_mov_b32 s49, s2
    v_mov_b32 v6, 0
    v_lshrrev_b32 v8, 3, v0
    v_and_b32 v9, 7, v0
    v_lshlrev_b32 v1, 4, v0
    v_mov_b32 v126, 0xffff0000
    s_and_b32 s53, s52, 3
    s_lshl_b32 s57, s54, 20
    s_add_u32 s57, s57, 0x200000
    s_getreg_b32 s58, hwreg(HW_REG_XCC_ID)
    s_mov_b32 s14, 0x10000000
    s_mov_b32 s15, 0x20000
    s_mov_b32 s22, 0x400
    s_mov_b32 s23, 0x20000
    s_mov_b32 s18, 0x300000
    s_mov_b32 s19, 0x20000
    s_lshl2_add_u32 s59, s52, 160768
    v_mov_b32 v7, s59
    ds_write2_b32 v7, v6, v6 offset0:0 offset1:8
    v_and_b32 v4, 3, v0
    v_lshlrev_b32 v4, 2, v4
    v_add_u32 v4, 160768, v4
    s_cmp_ge_u32 s52, 4
    s_cbranch_scc1 L_helper
    s_setprio 2
    s_mov_b32 s6, 0x200000
    s_mov_b32 s7, 0x20000
    v_lshlrev_b32 v2, 4, v9
    v_lshl_add_u32 v89, v8, 10, v2
    s_lshl4_add_u32 s61, s54, s55
    s_lshl_b32 s61, s61, 13
    s_lshl_b32 s62, s53, 8
    s_add_u32 s61, s61, s62
    s_lshl_b32 s64, s53, 11
    s_add_u32 s64, s64, 98304
    s_waitcnt lgkmcnt(0)
    buffer_load_dword v127, v6, s[12:15], 0 offen sc1
    s_cmp_ge_u32 s49, 32
    s_cbranch_scc1 L_p0a_skip
    s_and_b32 s59, s49, 1
    s_lshl2_add_u32 s59, s59, s53
    v_and_b32 v13, 3, v0
    v_lshlrev_b32 v13, 2, v13
    v_lshl_add_u32 v13, v8, 4, v13
    s_lshl_b32 s60, s59, 7
    buffer_load_dword v12, v13, s[20:23], s60 offen
    v_mul_u32_u24 v14, 49152, v8
    v_lshl_add_u32 v14, v9, 4, v14
    s_mul_i32 s59, s59, 393216
    s_lshr_b32 s60, s49, 1
    s_lshl_b32 s60, s60, 7
    s_add_u32 s59, s59, s60
    buffer_load_dwordx4 v[32:35], v14, s[16:19], s59 offen
    s_add_u32 s59, s59, 6144
    buffer_load_dwordx4 v[36:39], v14, s[16:19], s59 offen
    s_add_u32 s59, s59, 6144
    buffer_load_dwordx4 v[40:43], v14, s[16:19], s59 offen
    s_add_u32 s59, s59, 6144
    buffer_load_dwordx4 v[44:47], v14, s[16:19], s59 offen
    s_add_u32 s59, s59, 6144
    buffer_load_dwordx4 v[48:51], v14, s[16:19], s59 offen
    s_add_u32 s59, s59, 6144
    buffer_load_dwordx4 v[52:55], v14, s[16:19], s59 offen
    s_add_u32 s59, s59, 6144
    buffer_load_dwordx4 v[56:59], v14, s[16:19], s59 offen
    s_add_u32 s59, s59, 6144
    buffer_load_dwordx4 v[60:63], v14, s[16:19], s59 offen
L_p0a_skip:
    s_barrier
    s_load_dwordx2 s[44:45], s[0:1], 80
    v_lshrrev_b32 v10, 4, v0
    v_and_b32 v11, 15, v0
    s_mov_b32 s46, 0x200000
    s_mov_b32 s47, 0x20000
    v_lshl_add_u32 v90, v9, 7, s64
    v_lshl_add_u32 v90, v8, 4, v90
    v_lshlrev_b32 v2, 2, v10
    v_sub_u32 v2, v11, v2
    v_cmp_gt_u32 vcc, 4, v2
    v_mov_b32 v20, 0x3f80
    v_mov_b32 v21, 0
    v_cndmask_b32 v20, 0, v20, vcc
    v_lshlrev_b32 v2, 4, v2
    v_lshlrev_b64 v[116:117], v2, v[20:21]
    v_mov_b32 v120, 0x3f803f80
    v_mov_b32 v121, 0x3f803f80
    v_mov_b32 v122, 0x3f803f80
    v_mov_b32 v123, 0x3f803f80
    v_mov_b32 v118, 0x3fb8aa3b
    v_mov_b32 v119, 0x3fb8aa3b
    v_lshrrev_b32 v2, 2, v11
    v_lshl_add_u32 v2, v10, 3, v2
    v_lshlrev_b32 v2, 6, v2
    v_and_b32 v3, 3, v0
    v_lshl_add_u32 v2, v3, 3, v2
    v_and_b32 v3, 1, v10
    v_lshl_add_u32 v124, v3, 5, v2
    v_xor_b32 v125, 32, v124
    v_lshlrev_b32 v5, 2, v11
    v_lshlrev_b32 v91, 5, v9
    v_lshl_add_u32 v91, v10, 3, v91
    v_lshlrev_b32 v92, 1, v91
    s_add_u32 s59, s62, 111616
    v_add_u32 v91, s59, v91
    v_lshlrev_b32 v11, 4, v9
    v_add_u32 v11, 112640, v11
    v_lshrrev_b32 v10, 5, v0
    v_lshl_add_u32 v10, v10, 7, v11
    s_lshl_b32 s59, s53, 2
    v_add_u32 v10, s59, v10
    s_lshl_b32 s66, s53, 10
    s_add_u32 s73, s66, 107520
    s_add_u32 s66, s66, 0x4000
    s_add_u32 s74, s66, 4096
    s_add_u32 s75, s66, 8192
    s_add_u32 s76, s66, 12288
    s_add_u32 s67, s57, 0x80800
    v_lshlrev_b32 v94, 5, v5
    s_lshr_b32 s68, s55, 2
    s_bfe_u32 s59, s55, 0x10001
    s_lshl3_add_u32 s68, s68, s59
    s_lshl2_add_u32 s68, s68, s53
    s_lshl_b32 s68, s68, 12
    s_and_b32 s59, s55, 1
    s_lshl_b32 s59, s59, 7
    s_add_u32 s68, s68, s59
    s_add_u32 s68, s68, s57
    s_lshr_b32 s59, s55, 2
    s_lshl_b32 s59, s59, 7
    s_and_b32 s60, s55, 3
    s_lshl2_add_u32 s60, s60, s53
    s_lshl2_add_u32 s59, s60, s59
    s_add_u32 s70, s57, 0x80000
    s_add_u32 s69, s70, s59
    s_lshl_b32 s59, s53, 7
    s_add_u32 s70, s70, s59
    s_lshl_b32 s71, s53, 17
    s_add_u32 s71, s71, s57
    s_add_u32 s72, s71, 16384
    s_lshl2_add_u32 s77, s55, s53
    s_lshl4_add_u32 s77, s77, s54
    s_lshl_b32 s77, s77, 10
    s_add_u32 s77, s77, 0x40000
    v_mov_b32 v72, 0
    v_mov_b32 v73, 0
    v_lshlrev_b32 v88, 8, v0
    s_cmp_ge_u32 s49, 32
    s_cbranch_scc1 L_w1
    s_waitcnt vmcnt(8)
    s_branch L_w2
L_w1:
    s_waitcnt vmcnt(0)
L_w2:
    s_mov_b32 m0, s64
    s_nop 0
    buffer_load_dwordx4 v89, s[4:7], s61 offen lds
    s_add_u32 m0, s64, 896
    s_nop 0
    buffer_load_dwordx4 v89, s[4:7], s61 offen offset:128 lds
    s_mov_b64 exec, 0xffff
    buffer_load_dword v88, v88, s[12:15], s68 offen
    s_mov_b64 exec, -1
    v_add_u32 v127, 1, v127
    s_nop 0
    v_readfirstlane_b32 s56, v127
    v_mov_b32 v96, s58
    v_mov_b32 v97, v127
    v_mov_b32 v98, s58
    v_mov_b32 v99, v127
    s_lshl_b32 s59, s55, 7
    s_add_u32 s59, s59, s67
    s_cmp_eq_u32 s53, 3
    s_cselect_b32 s60, 0, 0x40000000
    v_add_u32 v95, s60, v1
    s_mov_b64 exec, 0xff
    buffer_store_dwordx4 v[96:99], v95, s[12:15], s59 offen sc1
    s_mov_b64 exec, -1
    s_cmp_ge_u32 s49, 32
    s_cbranch_scc1 L_p0c_skip
    v_lshlrev_b32 v13, 16, v12
    v_and_b32 v14, v126, v12
    v_mul_f32 v15, 0xbfb8aa3b, v13
    v_mul_f32 v16, 0xbfb8aa3b, v14
    v_exp_f32 v15, v15
    v_exp_f32 v16, v16
    s_mov_b32 s59, 0x05040100
    s_mov_b32 s60, 0x07060302
    v_add_f32 v15, 1.0, v15
    v_add_f32 v16, 1.0, v16
    v_rcp_f32 v15, v15
    v_rcp_f32 v16, v16
    v_mov_b32 v24, 0
    v_mov_b32 v25, 0
    v_mov_b32 v26, 0
    v_mov_b32 v27, 0
    v_mov_b32 v28, 0
    v_mov_b32 v29, 0
    v_mov_b32 v30, 0
    v_mov_b32 v31, 0
    v_mul_f32 v13, v13, v15
    v_mul_f32 v14, v14, v16
    v_cvt_pk_bf16_f32 v12, v13, v14
    s_nop 1
    v_mov_b32_dpp v16, v12 quad_perm:[0,0,0,0] row_mask:0xf bank_mask:0xf
    v_mov_b32_dpp v17, v12 quad_perm:[1,1,1,1] row_mask:0xf bank_mask:0xf
    v_mov_b32_dpp v18, v12 quad_perm:[2,2,2,2] row_mask:0xf bank_mask:0xf
    v_mov_b32_dpp v19, v12 quad_perm:[3,3,3,3] row_mask:0xf bank_mask:0xf
    s_waitcnt vmcnt(10)
    v_perm_b32 v20, v36, v32, s59
    v_perm_b32 v21, v36, v32, s60
    v_perm_b32 v22, v37, v33, s59
    v_perm_b32 v23, v37, v33, s60
    v_dot2c_f32_bf16 v24, v20, v16
    v_dot2c_f32_bf16 v25, v21, v16
    v_dot2c_f32_bf16 v26, v22, v16
    v_dot2c_f32_bf16 v27, v23, v16
    v_perm_b32 v20, v38, v34, s59
    v_perm_b32 v21, v38, v34, s60
    v_perm_b32 v22, v39, v35, s59
    v_perm_b32 v23, v39, v35, s60
    v_dot2c_f32_bf16 v28, v20, v16
    v_dot2c_f32_bf16 v29, v21, v16
    v_dot2c_f32_bf16 v30, v22, v16
    v_dot2c_f32_bf16 v31, v23, v16
    s_waitcnt vmcnt(8)
    v_perm_b32 v20, v44, v40, s59
    v_perm_b32 v21, v44, v40, s60
    v_perm_b32 v22, v45, v41, s59
    v_perm_b32 v23, v45, v41, s60
    v_dot2c_f32_bf16 v24, v20, v17
    v_dot2c_f32_bf16 v25, v21, v17
    v_dot2c_f32_bf16 v26, v22, v17
    v_dot2c_f32_bf16 v27, v23, v17
    v_perm_b32 v20, v46, v42, s59
    v_perm_b32 v21, v46, v42, s60
    v_perm_b32 v22, v47, v43, s59
    v_perm_b32 v23, v47, v43, s60
    v_dot2c_f32_bf16 v28, v20, v17
    v_dot2c_f32_bf16 v29, v21, v17
    v_dot2c_f32_bf16 v30, v22, v17
    v_dot2c_f32_bf16 v31, v23, v17
    s_waitcnt vmcnt(6)
    v_perm_b32 v20, v52, v48, s59
    v_perm_b32 v21, v52, v48, s60
    v_perm_b32 v22, v53, v49, s59
    v_perm_b32 v23, v53, v49, s60
    v_dot2c_f32_bf16 v24, v20, v18
    v_dot2c_f32_bf16 v25, v21, v18
    v_dot2c_f32_bf16 v26, v22, v18
    v_dot2c_f32_bf16 v27, v23, v18
    v_perm_b32 v20, v54, v50, s59
    v_perm_b32 v21, v54, v50, s60
    v_perm_b32 v22, v55, v51, s59
    v_perm_b32 v23, v55, v51, s60
    v_dot2c_f32_bf16 v28, v20, v18
    v_dot2c_f32_bf16 v29, v21, v18
    v_dot2c_f32_bf16 v30, v22, v18
    v_dot2c_f32_bf16 v31, v23, v18
    s_waitcnt vmcnt(4)
    v_perm_b32 v20, v60, v56, s59
    v_perm_b32 v21, v60, v56, s60
    v_perm_b32 v22, v61, v57, s59
    v_perm_b32 v23, v61, v57, s60
    v_dot2c_f32_bf16 v24, v20, v19
    v_dot2c_f32_bf16 v25, v21, v19
    v_dot2c_f32_bf16 v26, v22, v19
    v_dot2c_f32_bf16 v27, v23, v19
    v_perm_b32 v20, v62, v58, s59
    v_perm_b32 v21, v62, v58, s60
    v_perm_b32 v22, v63, v59, s59
    v_perm_b32 v23, v63, v59, s60
    v_dot2c_f32_bf16 v28, v20, v19
    v_dot2c_f32_bf16 v29, v21, v19
    v_dot2c_f32_bf16 v30, v22, v19
    v_dot2c_f32_bf16 v31, v23, v19
    v_permlane32_swap_b32 v24, v28
    v_permlane32_swap_b32 v25, v29
    v_permlane32_swap_b32 v26, v30
    v_permlane32_swap_b32 v27, v31
    v_pk_add_f32 v[24:25], v[24:25], v[28:29]
    v_pk_add_f32 v[26:27], v[26:27], v[30:31]
    s_nop 1
    v_permlane16_swap_b32 v24, v26
    v_permlane16_swap_b32 v25, v27
    v_pk_add_f32 v[24:25], v[24:25], v[26:27]
    s_nop 1
    v_add_f32_dpp v26, v24, v24 row_ror:8 row_mask:0xf bank_mask:0xf
    v_add_f32_dpp v27, v25, v25 row_ror:8 row_mask:0xf bank_mask:0xf
    ds_write_b64 v91, v[26:27]
    v_mov_b32 v2, 1
    ds_write_b32 v7, v2
    s_cmp_lg_u32 s52, 0
    s_cbranch_scc1 L_p0c_skip
    v_lshlrev_b32 v2, 2, v0
    v_add_u32 v3, 111616, v2
    s_lshr_b32 s59, s49, 4
    s_and_b32 s60, s49, 1
    s_lshl1_add_u32 s59, s59, s60
    s_bfe_u32 s60, s49, 0x30001
    s_lshl3_add_u32 s59, s59, s60
    s_lshl_b32 s59, s59, 9
    s_add_u32 s59, s59, 0x4000
    s_mov_b32 s63, 2097152
L_lw_1:
    ds_read_b32 v2, v4 offset:0
    ds_read2st64_b32 v[12:13], v3 offset0:0 offset1:1
    ds_read2st64_b32 v[14:15], v3 offset0:2 offset1:3
    s_sub_u32 s63, s63, 1
    s_cbranch_scc1 L_lwd_2
    s_waitcnt lgkmcnt(2)
    v_cmp_gt_u32 vcc, 1, v2
    s_nop 0
    s_cbranch_vccnz L_lw_1
L_lwd_2:
    v_lshlrev_b32 v2, 3, v0
    s_waitcnt lgkmcnt(0)
    v_pk_add_f32 v[12:13], v[12:13], v[14:15]
    v_add_f32 v12, v12, v13
    v_mov_b32 v13, v127
    buffer_store_dwordx2 v[12:13], v2, s[12:15], s59 offen sc1
    s_waitcnt vmcnt(3)
    s_branch L_xw
L_p0c_skip:
    s_waitcnt vmcnt(2)
L_xw:
    ds_read_b128 v[64:67], v90
    ds_read_b128 v[68:71], v90 offset:1024
    s_waitcnt lgkmcnt(0)
    v_dot2c_f32_bf16 v72, v120, v64
    v_dot2c_f32_bf16 v73, v64, v64
    v_dot2c_f32_bf16 v72, v120, v65
    v_dot2c_f32_bf16 v73, v65, v65
    v_dot2c_f32_bf16 v72, v120, v66
    v_dot2c_f32_bf16 v73, v66, v66
    v_dot2c_f32_bf16 v72, v120, v67
    v_dot2c_f32_bf16 v73, v67, v67
    v_dot2c_f32_bf16 v72, v120, v68
    v_dot2c_f32_bf16 v73, v68, v68
    v_dot2c_f32_bf16 v72, v120, v69
    v_dot2c_f32_bf16 v73, v69, v69
    v_dot2c_f32_bf16 v72, v120, v70
    v_dot2c_f32_bf16 v73, v70, v70
    v_dot2c_f32_bf16 v72, v120, v71
    v_dot2c_f32_bf16 v73, v71, v71
    s_nop 2
    v_permlane32_swap_b32 v72, v73
    v_add_f32 v72, v72, v73
    v_mov_b32 v73, v72
    s_nop 1
    v_permlane16_swap_b32 v72, v73
    v_add_f32 v72, v72, v73
    s_nop 1
    v_add_f32_dpp v73, v72, v72 row_ror:8 row_mask:0xf bank_mask:0xf
    ds_write_b32 v10, v73
    v_mov_b32 v2, 2
    ds_write_b32 v7, v2
    s_lshr_b32 s59, s55, 3
    s_lshl1_add_u32 s59, s54, s59
    s_lshl2_add_u32 s59, s59, s53
    s_lshl_b32 s3, s59, 14
    s_and_b32 s59, s55, 7
    s_lshl_b32 s59, s59, 7
    s_add_u32 s3, s3, s59
    v_lshrrev_b32 v2, 4, v0
    v_and_b32 v3, 7, v0
    v_xor_b32 v2, v2, v3
    v_lshrrev_b32 v3, 3, v0
    v_lshlrev_b32 v3, 10, v3
    v_lshl_add_u32 v100, v2, 4, v3
    v_xor_b32 v101, 8256, v100
    s_add_u32 m0, s64, 54272
    s_nop 0
    buffer_load_dwordx4 v100, s[4:7], s3 offen lds
    s_add_u32 m0, s64, 55296
    s_nop 0
    buffer_load_dwordx4 v101, s[4:7], s3 offen lds
    s_mov_b32 s63, 2097152
L_lw_3:
    ds_read_b32 v2, v4 offset:0
    s_sub_u32 s63, s63, 1
    s_cbranch_scc1 L_lwd_4
    s_waitcnt lgkmcnt(0)
    v_cmp_gt_u32 vcc, 2, v2
    s_nop 0
    s_cbranch_vccnz L_lw_3
L_lwd_4:
    ds_read_b128 v[16:19], v11
    ds_read_b128 v[20:23], v11 offset:128
    v_lshlrev_b32 v72, 16, v64
    v_and_b32 v73, v126, v64
    v_lshlrev_b32 v74, 16, v65
    v_and_b32 v75, v126, v65
    v_lshlrev_b32 v76, 16, v66
    v_and_b32 v77, v126, v66
    v_lshlrev_b32 v78, 16, v67
    v_and_b32 v79, v126, v67
    v_lshlrev_b32 v80, 16, v68
    v_and_b32 v81, v126, v68
    v_lshlrev_b32 v82, 16, v69
    v_and_b32 v83, v126, v69
    v_lshlrev_b32 v84, 16, v70
    v_and_b32 v85, v126, v70
    v_lshlrev_b32 v86, 16, v71
    v_and_b32 v87, v126, v71
    v_lshl_add_u32 v2, v0, 3, s73
    v_lshl_add_u32 v3, v8, 5, s73
    v_lshlrev_b32 v93, 8, v8
    v_lshl_add_u32 v93, v9, 4, v93
    s_waitcnt lgkmcnt(0)
    v_pk_add_f32 v[16:17], v[16:17], v[18:19]
    v_pk_add_f32 v[20:21], v[20:21], v[22:23]
    v_add_f32 v16, v16, v17
    v_add_f32 v17, v20, v21
    v_mul_f32 v16, 0x3b000000, v16
    v_mul_f32 v17, 0x3b000000, v17
    v_fma_f32 v17, -v16, v16, v17
    v_max_f32 v17, 0, v17
    v_add_f32 v17, 0x3727c5ac, v17
    v_rsq_f32 v17, v17
    s_nop 0
    v_mul_f32_e64 v16, -v16, v17
    v_pk_fma_f32 v[72:73], v[72:73], v[16:17], v[16:17] op_sel:[0,1,0] op_sel_hi:[1,1,0]
    v_pk_fma_f32 v[74:75], v[74:75], v[16:17], v[16:17] op_sel:[0,1,0] op_sel_hi:[1,1,0]
    v_pk_fma_f32 v[76:77], v[76:77], v[16:17], v[16:17] op_sel:[0,1,0] op_sel_hi:[1,1,0]
    v_pk_fma_f32 v[78:79], v[78:79], v[16:17], v[16:17] op_sel:[0,1,0] op_sel_hi:[1,1,0]
    v_pk_fma_f32 v[80:81], v[80:81], v[16:17], v[16:17] op_sel:[0,1,0] op_sel_hi:[1,1,0]
    v_pk_fma_f32 v[82:83], v[82:83], v[16:17], v[16:17] op_sel:[0,1,0] op_sel_hi:[1,1,0]
    v_pk_fma_f32 v[84:85], v[84:85], v[16:17], v[16:17] op_sel:[0,1,0] op_sel_hi:[1,1,0]
    v_pk_fma_f32 v[86:87], v[86:87], v[16:17], v[16:17] op_sel:[0,1,0] op_sel_hi:[1,1,0]
    v_lshlrev_b32 v14, 3, v0
    v_add_u32 v14, 106496, v14
    s_mov_b32 s63, 2097152
L_lw_5:
    ds_read_b32 v13, v4 offset:16
    s_sub_u32 s63, s63, 1
    s_cbranch_scc1 L_lwd_6
    s_waitcnt lgkmcnt(0)
    v_cmp_gt_u32 vcc, 1, v13
    s_nop 0
    s_cbranch_vccz L_lwd_6
    s_sleep 1
    s_branch L_lw_5
L_lwd_6:
    s_mov_b32 s63, 262144
    s_branch L_s0f
L_s0:
    s_sleep 4
L_s0f:
    buffer_load_dwordx4 v[16:19], v1, s[12:15], s66 offen sc1
    buffer_load_dwordx4 v[20:23], v1, s[12:15], s74 offen sc1
    buffer_load_dwordx4 v[24:27], v1, s[12:15], s75 offen sc1
    buffer_load_dwordx4 v[28:31], v1, s[12:15], s76 offen sc1
    buffer_load_dwordx2 v[32:33], v94, s[12:15], s67 offen sc1
    s_sub_u32 s63, s63, 1
    s_cbranch_scc1 L_s0d
    s_waitcnt vmcnt(0)
    v_xor_b32 v36, v127, v33
    v_xor_b32 v37, v127, v17
    v_bitop3_b32 v37, v37, v19, v127 bitop3:0xf6
    v_bitop3_b32 v36, v36, v21, v127 bitop3:0xf6
    v_bitop3_b32 v37, v37, v23, v127 bitop3:0xf6
    v_bitop3_b32 v36, v36, v25, v127 bitop3:0xf6
    v_bitop3_b32 v37, v37, v27, v127 bitop3:0xf6
    v_bitop3_b32 v36, v36, v29, v127 bitop3:0xf6
    v_bitop3_b32 v37, v37, v31, v127 bitop3:0xf6
    v_or_b32 v36, v36, v37
    v_cmp_ne_u32 vcc, 0, v36
    s_nop 0
    s_cbranch_vccnz L_s0
L_s0d:
    s_waitcnt vmcnt(0)
    v_add_f32 v24, v24, v28
    v_add_f32 v26, v26, v30
    v_add_f32 v16, v16, v20
    v_add_f32 v18, v18, v22
    v_cvt_pk_bf16_f32 v24, v24, v26
    v_cvt_pk_bf16_f32 v16, v16, v18
    v_and_b32 v25, v126, v24
    v_lshlrev_b32 v24, 16, v24
    v_and_b32 v17, v126, v16
    v_lshlrev_b32 v16, 16, v16
    v_add_f32 v24, 1.0, v24
    v_add_f32 v25, 1.0, v25
    ds_write_b64 v2, v[16:17]
    v_cvt_pk_bf16_f32 v24, v24, v25
    v_and_b32 v25, v126, v24
    v_lshlrev_b32 v24, 16, v24
    ds_write_b64 v2, v[24:25] offset:512
    ds_read_b128 v[16:19], v3 offset:0
    ds_read_b128 v[40:43], v3 offset:512
    ds_read_b128 v[20:23], v3 offset:16
    ds_read_b128 v[44:47], v3 offset:528
    ds_read_b128 v[24:27], v3 offset:256
    ds_read_b128 v[48:51], v3 offset:768
    ds_read_b128 v[28:31], v3 offset:272
    ds_read_b128 v[52:55], v3 offset:784
    v_cmp_ne_u32 vcc, s58, v32
    s_nop 0
    s_cmp_eq_u64 vcc, 0
    s_cselect_b32 s58, 1, 0
    s_waitcnt lgkmcnt(6)
    v_pk_fma_f32 v[16:17], v[72:73], v[40:41], v[16:17]
    v_pk_fma_f32 v[18:19], v[74:75], v[42:43], v[18:19]
    v_cvt_pk_bf16_f32 v32, v16, v17
    v_cvt_pk_bf16_f32 v33, v18, v19
    s_waitcnt lgkmcnt(4)
    v_pk_fma_f32 v[20:21], v[76:77], v[44:45], v[20:21]
    v_pk_fma_f32 v[22:23], v[78:79], v[46:47], v[22:23]
    v_cvt_pk_bf16_f32 v34, v20, v21
    v_cvt_pk_bf16_f32 v35, v22, v23
    s_waitcnt lgkmcnt(2)
    v_pk_fma_f32 v[24:25], v[80:81], v[48:49], v[24:25]
    v_pk_fma_f32 v[26:27], v[82:83], v[50:51], v[26:27]
    v_cvt_pk_bf16_f32 v36, v24, v25
    v_cvt_pk_bf16_f32 v37, v26, v27
    s_waitcnt lgkmcnt(0)
    v_pk_fma_f32 v[28:29], v[84:85], v[52:53], v[28:29]
    v_pk_fma_f32 v[30:31], v[86:87], v[54:55], v[30:31]
    v_cvt_pk_bf16_f32 v38, v28, v29
    v_cvt_pk_bf16_f32 v39, v30, v31
    s_cmp_eq_u32 s58, 0
    s_cbranch_scc1 L_slow_7
    buffer_store_dwordx4 v[32:35], v93, s[12:15], s68 offen
    buffer_store_dwordx4 v[36:39], v93, s[12:15], s68 offen offset:2048
L_sd_8:
    s_mov_b64 exec, 1
    s_cmp_eq_u32 s58, 0
    s_cbranch_scc1 L_slow_9
    s_waitcnt vmcnt(0)
    buffer_store_dword v127, v6, s[12:15], s69 offen
L_sd_10:
    s_mov_b64 exec, -1
    s_mov_b32 s63, 2097152
L_lw_11:
    ds_read_b32 v13, v4 offset:16
    s_sub_u32 s63, s63, 1
    s_cbranch_scc1 L_lwd_12
    s_waitcnt lgkmcnt(0)
    v_cmp_gt_u32 vcc, 2, v13
    s_nop 0
    s_cbranch_vccz L_lwd_12
    s_sleep 1
    s_branch L_lw_11
L_lwd_12:
    ds_read_b64_tr_b16 v[112:113], v14 offset:0
    ds_read_b64_tr_b16 v[114:115], v14 offset:512
    s_waitcnt lgkmcnt(0)
    ds_read_b64_tr_b16 v[64:65], v124 offset:0
    ds_read_b64_tr_b16 v[66:67], v124 offset:256
    ds_read_b64_tr_b16 v[68:69], v125 offset:0
    ds_read_b64_tr_b16 v[70:71], v125 offset:256
    ds_read_b64_tr_b16 v[72:73], v124 offset:32768
    ds_read_b64_tr_b16 v[74:75], v124 offset:33024
    ds_read_b64_tr_b16 v[76:77], v125 offset:32768
    ds_read_b64_tr_b16 v[78:79], v125 offset:33024
    ds_read_b64_tr_b16 v[80:81], v124 offset:2048
    ds_read_b64_tr_b16 v[82:83], v124 offset:2304
    ds_read_b64_tr_b16 v[84:85], v125 offset:2048
    ds_read_b64_tr_b16 v[86:87], v125 offset:2304
    ds_read_b64_tr_b16 v[88:89], v124 offset:34816
    ds_read_b64_tr_b16 v[90:91], v124 offset:35072
    ds_read_b64_tr_b16 v[92:93], v125 offset:34816
    ds_read_b64_tr_b16 v[94:95], v125 offset:35072
    s_mov_b32 s63, 262144
L_poll_13:
    buffer_load_dword v10, v5, s[12:15], s70 offen sc1
    s_sub_u32 s63, s63, 1
    s_cbranch_scc1 L_pd_14
    s_waitcnt vmcnt(0)
    v_cmp_ne_u32 vcc, s56, v10
    s_nop 0
    s_cbranch_vccnz L_poll_13
L_pd_14:
    buffer_load_dwordx4 a[0:3], v1, s[12:15], s71 offen offset:0 sc1
    buffer_load_dwordx4 a[4:7], v1, s[12:15], s72 offen offset:0 sc1
    buffer_load_dwordx4 a[8:11], v1, s[12:15], s71 offen offset:1024 sc1
    buffer_load_dwordx4 a[12:15], v1, s[12:15], s72 offen offset:1024 sc1
    buffer_load_dwordx4 a[16:19], v1, s[12:15], s71 offen offset:2048 sc1
    buffer_load_dwordx4 a[20:23], v1, s[12:15], s72 offen offset:2048 sc1
    buffer_load_dwordx4 a[24:27], v1, s[12:15], s71 offen offset:3072 sc1
    buffer_load_dwordx4 a[28:31], v1, s[12:15], s72 offen offset:3072 sc1
    s_add_u32 s71, s71, 4096
    s_add_u32 s72, s72, 4096
    s_waitcnt vmcnt(6) lgkmcnt(8)
    v_mfma_f32_16x16x32_bf16 v[32:35], v[64:67], a[0:3], 0
    buffer_load_dwordx4 a[32:35], v1, s[12:15], s71 offen offset:0 sc1
    buffer_load_dwordx4 a[36:39], v1, s[12:15], s72 offen offset:0 sc1
    v_mfma_f32_16x16x32_bf16 v[36:39], v[64:67], a[4:7], 0
    ds_read_b64_tr_b16 v[96:97], v124 offset:4096
    ds_read_b64_tr_b16 v[98:99], v124 offset:4352
    v_mfma_f32_16x16x32_bf16 v[40:43], v[68:71], a[0:3], 0
    ds_read_b64_tr_b16 v[100:101], v125 offset:4096
    v_mfma_f32_16x16x32_bf16 v[44:47], v[68:71], a[4:7], 0
    ds_read_b64_tr_b16 v[102:103], v125 offset:4352
    v_mfma_f32_16x16x32_bf16 v[48:51], a[0:3], v[72:75], 0
    ds_read_b64_tr_b16 v[104:105], v124 offset:36864
    v_mfma_f32_16x16x32_bf16 v[52:55], a[4:7], v[72:75], 0
    ds_read_b64_tr_b16 v[106:107], v124 offset:37120
    v_mfma_f32_16x16x32_bf16 v[56:59], a[0:3], v[76:79], 0
    ds_read_b64_tr_b16 v[108:109], v125 offset:36864
    v_mfma_f32_16x16x32_bf16 v[60:63], a[4:7], v[76:79], 0
    ds_read_b64_tr_b16 v[110:111], v125 offset:37120
    s_waitcnt vmcnt(6) lgkmcnt(8)
    v_mfma_f32_16x16x32_bf16 v[32:35], v[80:83], a[8:11], v[32:35]
    buffer_load_dwordx4 a[40:43], v1, s[12:15], s71 offen offset:1024 sc1
    buffer_load_dwordx4 a[44:47], v1, s[12:15], s72 offen offset:1024 sc1
    v_mfma_f32_16x16x32_bf16 v[36:39], v[80:83], a[12:15], v[36:39]
    ds_read_b64_tr_b16 v[64:65], v124 offset:6144
    ds_read_b64_tr_b16 v[66:67], v124 offset:6400
    v_mfma_f32_16x16x32_bf16 v[40:43], v[84:87], a[8:11], v[40:43]
    ds_read_b64_tr_b16 v[68:69], v125 offset:6144
    v_mfma_f32_16x16x32_bf16 v[44:47], v[84:87], a[12:15], v[44:47]
    ds_read_b64_tr_b16 v[70:71], v125 offset:6400
    v_mfma_f32_16x16x32_bf16 v[48:51], a[8:11], v[88:91], v[48:51]
    ds_read_b64_tr_b16 v[72:73], v124 offset:38912
    v_mfma_f32_16x16x32_bf16 v[52:55], a[12:15], v[88:91], v[52:55]
    ds_read_b64_tr_b16 v[74:75], v124 offset:39168
    v_mfma_f32_16x16x32_bf16 v[56:59], a[8:11], v[92:95], v[56:59]
    ds_read_b64_tr_b16 v[76:77], v125 offset:38912
    v_mfma_f32_16x16x32_bf16 v[60:63], a[12:15], v[92:95], v[60:63]
    ds_read_b64_tr_b16 v[78:79], v125 offset:39168
    s_waitcnt vmcnt(6) lgkmcnt(8)
    v_mfma_f32_16x16x32_bf16 v[32:35], v[96:99], a[16:19], v[32:35]
    buffer_load_dwordx4 a[48:51], v1, s[12:15], s71 offen offset:2048 sc1
    buffer_load_dwordx4 a[52:55], v1, s[12:15], s72 offen offset:2048 sc1
    v_mfma_f32_16x16x32_bf16 v[36:39], v[96:99], a[20:23], v[36:39]
    ds_read_b64_tr_b16 v[80:81], v124 offset:8192
    ds_read_b64_tr_b16 v[82:83], v124 offset:8448
    v_mfma_f32_16x16x32_bf16 v[40:43], v[100:103], a[16:19], v[40:43]
    ds_read_b64_tr_b16 v[84:85], v125 offset:8192
    v_mfma_f32_16x16x32_bf16 v[44:47], v[100:103], a[20:23], v[44:47]
    ds_read_b64_tr_b16 v[86:87], v125 offset:8448
    v_mfma_f32_16x16x32_bf16 v[48:51], a[16:19], v[104:107], v[48:51]
    ds_read_b64_tr_b16 v[88:89], v124 offset:40960
    v_mfma_f32_16x16x32_bf16 v[52:55], a[20:23], v[104:107], v[52:55]
    ds_read_b64_tr_b16 v[90:91], v124 offset:41216
    v_mfma_f32_16x16x32_bf16 v[56:59], a[16:19], v[108:111], v[56:59]
    ds_read_b64_tr_b16 v[92:93], v125 offset:40960
    v_mfma_f32_16x16x32_bf16 v[60:63], a[20:23], v[108:111], v[60:63]
    ds_read_b64_tr_b16 v[94:95], v125 offset:41216
    s_waitcnt vmcnt(6) lgkmcnt(8)
    v_mfma_f32_16x16x32_bf16 v[32:35], v[64:67], a[24:27], v[32:35]
    buffer_load_dwordx4 a[56:59], v1, s[12:15], s71 offen offset:3072 sc1
    buffer_load_dwordx4 a[60:63], v1, s[12:15], s72 offen offset:3072 sc1
    v_mfma_f32_16x16x32_bf16 v[36:39], v[64:67], a[28:31], v[36:39]
    s_add_u32 s71, s71, 4096
    s_add_u32 s72, s72, 4096
    v_mfma_f32_16x16x32_bf16 v[40:43], v[68:71], a[24:27], v[40:43]
    ds_read_b64_tr_b16 v[96:97], v124 offset:10240
    ds_read_b64_tr_b16 v[98:99], v124 offset:10496
    v_mfma_f32_16x16x32_bf16 v[44:47], v[68:71], a[28:31], v[44:47]
    ds_read_b64_tr_b16 v[100:101], v125 offset:10240
    ds_read_b64_tr_b16 v[102:103], v125 offset:10496
    v_mfma_f32_16x16x32_bf16 v[48:51], a[24:27], v[72:75], v[48:51]
    ds_read_b64_tr_b16 v[104:105], v124 offset:43008
    v_mfma_f32_16x16x32_bf16 v[52:55], a[28:31], v[72:75], v[52:55]
    ds_read_b64_tr_b16 v[106:107], v124 offset:43264
    v_mfma_f32_16x16x32_bf16 v[56:59], a[24:27], v[76:79], v[56:59]
    ds_read_b64_tr_b16 v[108:109], v125 offset:43008
    v_mfma_f32_16x16x32_bf16 v[60:63], a[28:31], v[76:79], v[60:63]
    ds_read_b64_tr_b16 v[110:111], v125 offset:43264
    s_waitcnt vmcnt(6) lgkmcnt(8)
    v_mfma_f32_16x16x32_bf16 v[32:35], v[80:83], a[32:35], v[32:35]
    buffer_load_dwordx4 a[64:67], v1, s[12:15], s71 offen offset:0 sc1
    buffer_load_dwordx4 a[68:71], v1, s[12:15], s72 offen offset:0 sc1
    v_mfma_f32_16x16x32_bf16 v[36:39], v[80:83], a[36:39], v[36:39]
    ds_read_b64_tr_b16 v[64:65], v124 offset:12288
    ds_read_b64_tr_b16 v[66:67], v124 offset:12544
    v_mfma_f32_16x16x32_bf16 v[40:43], v[84:87], a[32:35], v[40:43]
    ds_read_b64_tr_b16 v[68:69], v125 offset:12288
    v_mfma_f32_16x16x32_bf16 v[44:47], v[84:87], a[36:39], v[44:47]
    ds_read_b64_tr_b16 v[70:71], v125 offset:12544
    v_mfma_f32_16x16x32_bf16 v[48:51], a[32:35], v[88:91], v[48:51]
    ds_read_b64_tr_b16 v[72:73], v124 offset:45056
    v_mfma_f32_16x16x32_bf16 v[52:55], a[36:39], v[88:91], v[52:55]
    ds_read_b64_tr_b16 v[74:75], v124 offset:45312
    v_mfma_f32_16x16x32_bf16 v[56:59], a[32:35], v[92:95], v[56:59]
    ds_read_b64_tr_b16 v[76:77], v125 offset:45056
    v_mfma_f32_16x16x32_bf16 v[60:63], a[36:39], v[92:95], v[60:63]
    ds_read_b64_tr_b16 v[78:79], v125 offset:45312
    s_waitcnt vmcnt(6) lgkmcnt(8)
    v_mfma_f32_16x16x32_bf16 v[32:35], v[96:99], a[40:43], v[32:35]
    buffer_load_dwordx4 a[72:75], v1, s[12:15], s71 offen offset:1024 sc1
    buffer_load_dwordx4 a[76:79], v1, s[12:15], s72 offen offset:1024 sc1
    v_mfma_f32_16x16x32_bf16 v[36:39], v[96:99], a[44:47], v[36:39]
    ds_read_b64_tr_b16 v[80:81], v124 offset:14336
    ds_read_b64_tr_b16 v[82:83], v124 offset:14592
    v_mfma_f32_16x16x32_bf16 v[40:43], v[100:103], a[40:43], v[40:43]
    ds_read_b64_tr_b16 v[84:85], v125 offset:14336
    v_mfma_f32_16x16x32_bf16 v[44:47], v[100:103], a[44:47], v[44:47]
    ds_read_b64_tr_b16 v[86:87], v125 offset:14592
    v_mfma_f32_16x16x32_bf16 v[48:51], a[40:43], v[104:107], v[48:51]
    ds_read_b64_tr_b16 v[88:89], v124 offset:47104
    v_mfma_f32_16x16x32_bf16 v[52:55], a[44:47], v[104:107], v[52:55]
    ds_read_b64_tr_b16 v[90:91], v124 offset:47360
    v_mfma_f32_16x16x32_bf16 v[56:59], a[40:43], v[108:111], v[56:59]
    ds_read_b64_tr_b16 v[92:93], v125 offset:47104
    v_mfma_f32_16x16x32_bf16 v[60:63], a[44:47], v[108:111], v[60:63]
    ds_read_b64_tr_b16 v[94:95], v125 offset:47360
    s_waitcnt vmcnt(6) lgkmcnt(8)
    v_mfma_f32_16x16x32_bf16 v[32:35], v[64:67], a[48:51], v[32:35]
    buffer_load_dwordx4 a[80:83], v1, s[12:15], s71 offen offset:2048 sc1
    buffer_load_dwordx4 a[84:87], v1, s[12:15], s72 offen offset:2048 sc1
    v_mfma_f32_16x16x32_bf16 v[36:39], v[64:67], a[52:55], v[36:39]
    ds_read_b64_tr_b16 v[96:97], v124 offset:16384
    ds_read_b64_tr_b16 v[98:99], v124 offset:16640
    v_mfma_f32_16x16x32_bf16 v[40:43], v[68:71], a[48:51], v[40:43]
    ds_read_b64_tr_b16 v[100:101], v125 offset:16384
    v_mfma_f32_16x16x32_bf16 v[44:47], v[68:71], a[52:55], v[44:47]
    ds_read_b64_tr_b16 v[102:103], v125 offset:16640
    v_mfma_f32_16x16x32_bf16 v[48:51], a[48:51], v[72:75], v[48:51]
    ds_read_b64_tr_b16 v[104:105], v124 offset:49152
    v_mfma_f32_16x16x32_bf16 v[52:55], a[52:55], v[72:75], v[52:55]
    ds_read_b64_tr_b16 v[106:107], v124 offset:49408
    v_mfma_f32_16x16x32_bf16 v[56:59], a[48:51], v[76:79], v[56:59]
    ds_read_b64_tr_b16 v[108:109], v125 offset:49152
    v_mfma_f32_16x16x32_bf16 v[60:63], a[52:55], v[76:79], v[60:63]
    ds_read_b64_tr_b16 v[110:111], v125 offset:49408
    s_waitcnt vmcnt(6) lgkmcnt(8)
    v_mfma_f32_16x16x32_bf16 v[32:35], v[80:83], a[56:59], v[32:35]
    buffer_load_dwordx4 a[88:91], v1, s[12:15], s71 offen offset:3072 sc1
    buffer_load_dwordx4 a[92:95], v1, s[12:15], s72 offen offset:3072 sc1
    v_mfma_f32_16x16x32_bf16 v[36:39], v[80:83], a[60:63], v[36:39]
    s_add_u32 s71, s71, 4096
    s_add_u32 s72, s72, 4096
    v_mfma_f32_16x16x32_bf16 v[40:43], v[84:87], a[56:59], v[40:43]
    ds_read_b64_tr_b16 v[64:65], v124 offset:18432
    ds_read_b64_tr_b16 v[66:67], v124 offset:18688
    v_mfma_f32_16x16x32_bf16 v[44:47], v[84:87], a[60:63], v[44:47]
    ds_read_b64_tr_b16 v[68:69], v125 offset:18432
    ds_read_b64_tr_b16 v[70:71], v125 offset:18688
    v_mfma_f32_16x16x32_bf16 v[48:51], a[56:59], v[88:91], v[48:51]
    ds_read_b64_tr_b16 v[72:73], v124 offset:51200
    v_mfma_f32_16x16x32_bf16 v[52:55], a[60:63], v[88:91], v[52:55]
    ds_read_b64_tr_b16 v[74:75], v124 offset:51456
    v_mfma_f32_16x16x32_bf16 v[56:59], a[56:59], v[92:95], v[56:59]
    ds_read_b64_tr_b16 v[76:77], v125 offset:51200
    v_mfma_f32_16x16x32_bf16 v[60:63], a[60:63], v[92:95], v[60:63]
    ds_read_b64_tr_b16 v[78:79], v125 offset:51456
    s_waitcnt vmcnt(6) lgkmcnt(8)
    v_mfma_f32_16x16x32_bf16 v[32:35], v[96:99], a[64:67], v[32:35]
    buffer_load_dwordx4 a[96:99], v1, s[12:15], s71 offen offset:0 sc1
    buffer_load_dwordx4 a[100:103], v1, s[12:15], s72 offen offset:0 sc1
    v_mfma_f32_16x16x32_bf16 v[36:39], v[96:99], a[68:71], v[36:39]
    ds_read_b64_tr_b16 v[80:81], v124 offset:20480
    ds_read_b64_tr_b16 v[82:83], v124 offset:20736
    v_mfma_f32_16x16x32_bf16 v[40:43], v[100:103], a[64:67], v[40:43]
    ds_read_b64_tr_b16 v[84:85], v125 offset:20480
    v_mfma_f32_16x16x32_bf16 v[44:47], v[100:103], a[68:71], v[44:47]
    ds_read_b64_tr_b16 v[86:87], v125 offset:20736
    v_mfma_f32_16x16x32_bf16 v[48:51], a[64:67], v[104:107], v[48:51]
    ds_read_b64_tr_b16 v[88:89], v124 offset:53248
    v_mfma_f32_16x16x32_bf16 v[52:55], a[68:71], v[104:107], v[52:55]
    ds_read_b64_tr_b16 v[90:91], v124 offset:53504
    v_mfma_f32_16x16x32_bf16 v[56:59], a[64:67], v[108:111], v[56:59]
    ds_read_b64_tr_b16 v[92:93], v125 offset:53248
    v_mfma_f32_16x16x32_bf16 v[60:63], a[68:71], v[108:111], v[60:63]
    ds_read_b64_tr_b16 v[94:95], v125 offset:53504
    s_waitcnt vmcnt(6) lgkmcnt(8)
    v_mfma_f32_16x16x32_bf16 v[32:35], v[64:67], a[72:75], v[32:35]
    buffer_load_dwordx4 a[104:107], v1, s[12:15], s71 offen offset:1024 sc1
    buffer_load_dwordx4 a[108:111], v1, s[12:15], s72 offen offset:1024 sc1
    v_mfma_f32_16x16x32_bf16 v[36:39], v[64:67], a[76:79], v[36:39]
    ds_read_b64_tr_b16 v[96:97], v124 offset:22528
    ds_read_b64_tr_b16 v[98:99], v124 offset:22784
    v_mfma_f32_16x16x32_bf16 v[40:43], v[68:71], a[72:75], v[40:43]
    ds_read_b64_tr_b16 v[100:101], v125 offset:22528
    v_mfma_f32_16x16x32_bf16 v[44:47], v[68:71], a[76:79], v[44:47]
    ds_read_b64_tr_b16 v[102:103], v125 offset:22784
    v_mfma_f32_16x16x32_bf16 v[48:51], a[72:75], v[72:75], v[48:51]
    ds_read_b64_tr_b16 v[104:105], v124 offset:55296
    v_mfma_f32_16x16x32_bf16 v[52:55], a[76:79], v[72:75], v[52:55]
    ds_read_b64_tr_b16 v[106:107], v124 offset:55552
    v_mfma_f32_16x16x32_bf16 v[56:59], a[72:75], v[76:79], v[56:59]
    ds_read_b64_tr_b16 v[108:109], v125 offset:55296
    v_mfma_f32_16x16x32_bf16 v[60:63], a[76:79], v[76:79], v[60:63]
    ds_read_b64_tr_b16 v[110:111], v125 offset:55552
    s_waitcnt vmcnt(6) lgkmcnt(8)
    v_mfma_f32_16x16x32_bf16 v[32:35], v[80:83], a[80:83], v[32:35]
    buffer_load_dwordx4 a[112:115], v1, s[12:15], s71 offen offset:2048 sc1
    buffer_load_dwordx4 a[116:119], v1, s[12:15], s72 offen offset:2048 sc1
    v_mfma_f32_16x16x32_bf16 v[36:39], v[80:83], a[84:87], v[36:39]
    ds_read_b64_tr_b16 v[64:65], v124 offset:24576
    ds_read_b64_tr_b16 v[66:67], v124 offset:24832
    v_mfma_f32_16x16x32_bf16 v[40:43], v[84:87], a[80:83], v[40:43]
    ds_read_b64_tr_b16 v[68:69], v125 offset:24576
    v_mfma_f32_16x16x32_bf16 v[44:47], v[84:87], a[84:87], v[44:47]
    ds_read_b64_tr_b16 v[70:71], v125 offset:24832
    v_mfma_f32_16x16x32_bf16 v[48:51], a[80:83], v[88:91], v[48:51]
    ds_read_b64_tr_b16 v[72:73], v124 offset:57344
    v_mfma_f32_16x16x32_bf16 v[52:55], a[84:87], v[88:91], v[52:55]
    ds_read_b64_tr_b16 v[74:75], v124 offset:57600
    v_mfma_f32_16x16x32_bf16 v[56:59], a[80:83], v[92:95], v[56:59]
    ds_read_b64_tr_b16 v[76:77], v125 offset:57344
    v_mfma_f32_16x16x32_bf16 v[60:63], a[84:87], v[92:95], v[60:63]
    ds_read_b64_tr_b16 v[78:79], v125 offset:57600
    s_waitcnt vmcnt(6) lgkmcnt(8)
    v_mfma_f32_16x16x32_bf16 v[32:35], v[96:99], a[88:91], v[32:35]
    buffer_load_dwordx4 a[120:123], v1, s[12:15], s71 offen offset:3072 sc1
    buffer_load_dwordx4 a[124:127], v1, s[12:15], s72 offen offset:3072 sc1
    v_mfma_f32_16x16x32_bf16 v[36:39], v[96:99], a[92:95], v[36:39]
    ds_read_b64_tr_b16 v[80:81], v124 offset:26624
    ds_read_b64_tr_b16 v[82:83], v124 offset:26880
    v_mfma_f32_16x16x32_bf16 v[40:43], v[100:103], a[88:91], v[40:43]
    ds_read_b64_tr_b16 v[84:85], v125 offset:26624
    v_mfma_f32_16x16x32_bf16 v[44:47], v[100:103], a[92:95], v[44:47]
    ds_read_b64_tr_b16 v[86:87], v125 offset:26880
    v_mfma_f32_16x16x32_bf16 v[48:51], a[88:91], v[104:107], v[48:51]
    ds_read_b64_tr_b16 v[88:89], v124 offset:59392
    v_mfma_f32_16x16x32_bf16 v[52:55], a[92:95], v[104:107], v[52:55]
    ds_read_b64_tr_b16 v[90:91], v124 offset:59648
    v_mfma_f32_16x16x32_bf16 v[56:59], a[88:91], v[108:111], v[56:59]
    ds_read_b64_tr_b16 v[92:93], v125 offset:59392
    v_mfma_f32_16x16x32_bf16 v[60:63], a[92:95], v[108:111], v[60:63]
    ds_read_b64_tr_b16 v[94:95], v125 offset:59648
    v_mov_b32 v10, 3
    ds_write_b32 v7, v10
    s_waitcnt vmcnt(6) lgkmcnt(9)
    v_mfma_f32_16x16x32_bf16 v[32:35], v[64:67], a[96:99], v[32:35]
    ds_read_b64_tr_b16 v[96:97], v124 offset:28672
    v_mfma_f32_16x16x32_bf16 v[36:39], v[64:67], a[100:103], v[36:39]
    ds_read_b64_tr_b16 v[98:99], v124 offset:28928
    v_mfma_f32_16x16x32_bf16 v[40:43], v[68:71], a[96:99], v[40:43]
    ds_read_b64_tr_b16 v[100:101], v125 offset:28672
    v_mfma_f32_16x16x32_bf16 v[44:47], v[68:71], a[100:103], v[44:47]
    ds_read_b64_tr_b16 v[102:103], v125 offset:28928
    v_mfma_f32_16x16x32_bf16 v[48:51], a[96:99], v[72:75], v[48:51]
    ds_read_b64_tr_b16 v[104:105], v124 offset:61440
    v_mfma_f32_16x16x32_bf16 v[52:55], a[100:103], v[72:75], v[52:55]
    ds_read_b64_tr_b16 v[106:107], v124 offset:61696
    v_mfma_f32_16x16x32_bf16 v[56:59], a[96:99], v[76:79], v[56:59]
    ds_read_b64_tr_b16 v[108:109], v125 offset:61440
    v_mfma_f32_16x16x32_bf16 v[60:63], a[100:103], v[76:79], v[60:63]
    ds_read_b64_tr_b16 v[110:111], v125 offset:61696
    s_waitcnt vmcnt(4) lgkmcnt(8)
    v_mfma_f32_16x16x32_bf16 v[32:35], v[80:83], a[104:107], v[32:35]
    ds_read_b64_tr_b16 v[64:65], v124 offset:30720
    v_mfma_f32_16x16x32_bf16 v[36:39], v[80:83], a[108:111], v[36:39]
    ds_read_b64_tr_b16 v[66:67], v124 offset:30976
    v_mfma_f32_16x16x32_bf16 v[40:43], v[84:87], a[104:107], v[40:43]
    ds_read_b64_tr_b16 v[68:69], v125 offset:30720
    v_mfma_f32_16x16x32_bf16 v[44:47], v[84:87], a[108:111], v[44:47]
    ds_read_b64_tr_b16 v[70:71], v125 offset:30976
    v_mfma_f32_16x16x32_bf16 v[48:51], a[104:107], v[88:91], v[48:51]
    ds_read_b64_tr_b16 v[72:73], v124 offset:63488
    v_mfma_f32_16x16x32_bf16 v[52:55], a[108:111], v[88:91], v[52:55]
    ds_read_b64_tr_b16 v[74:75], v124 offset:63744
    v_mfma_f32_16x16x32_bf16 v[56:59], a[104:107], v[92:95], v[56:59]
    ds_read_b64_tr_b16 v[76:77], v125 offset:63488
    v_mfma_f32_16x16x32_bf16 v[60:63], a[108:111], v[92:95], v[60:63]
    ds_read_b64_tr_b16 v[78:79], v125 offset:63744
    s_waitcnt vmcnt(2) lgkmcnt(8)
    v_mfma_f32_16x16x32_bf16 v[32:35], v[96:99], a[112:115], v[32:35]
    v_mfma_f32_16x16x32_bf16 v[36:39], v[96:99], a[116:119], v[36:39]
    v_mfma_f32_16x16x32_bf16 v[40:43], v[100:103], a[112:115], v[40:43]
    v_mfma_f32_16x16x32_bf16 v[44:47], v[100:103], a[116:119], v[44:47]
    v_mfma_f32_16x16x32_bf16 v[48:51], a[112:115], v[104:107], v[48:51]
    v_mfma_f32_16x16x32_bf16 v[52:55], a[116:119], v[104:107], v[52:55]
    v_mfma_f32_16x16x32_bf16 v[56:59], a[112:115], v[108:111], v[56:59]
    v_mfma_f32_16x16x32_bf16 v[60:63], a[116:119], v[108:111], v[60:63]
    s_waitcnt vmcnt(0) lgkmcnt(0)
    v_mfma_f32_16x16x32_bf16 v[32:35], v[64:67], a[120:123], v[32:35]
    v_mfma_f32_16x16x32_bf16 v[36:39], v[64:67], a[124:127], v[36:39]
    v_mfma_f32_16x16x32_bf16 v[40:43], v[68:71], a[120:123], v[40:43]
    v_mfma_f32_16x16x32_bf16 v[44:47], v[68:71], a[124:127], v[44:47]
    v_mfma_f32_16x16x32_bf16 v[48:51], a[120:123], v[72:75], v[48:51]
    v_mfma_f32_16x16x32_bf16 v[52:55], a[124:127], v[72:75], v[52:55]
    v_mfma_f32_16x16x32_bf16 v[56:59], a[120:123], v[76:79], v[56:59]
    v_mfma_f32_16x16x32_bf16 v[60:63], a[124:127], v[76:79], v[60:63]
    v_mov_b32 v10, 4
    ds_write_b32 v7, v10
    s_mul_i32 s59, s53, 4352
    s_add_u32 s59, s59, 135168
    v_add_u32 v2, s59, v1
    v_and_b32 v3, 48, v0
    v_add_u32 v3, s59, v3
    v_cvt_pk_bf16_f32 v8, v32, v33
    v_cvt_pk_bf16_f32 v9, v34, v35
    v_cvt_pk_bf16_f32 v10, v36, v37
    v_cvt_pk_bf16_f32 v11, v38, v39
    v_cvt_pk_bf16_f32 v12, v40, v41
    v_cvt_pk_bf16_f32 v13, v42, v43
    v_cvt_pk_bf16_f32 v14, v44, v45
    v_cvt_pk_bf16_f32 v15, v46, v47
    v_mfma_f32_16x16x16_bf16 v[64:67], v[112:113], v[8:9], 0
    v_mfma_f32_16x16x16_bf16 v[68:71], v[112:113], v[10:11], 0
    v_mfma_f32_16x16x16_bf16 v[72:75], v[114:115], v[12:13], 0
    v_mfma_f32_16x16x16_bf16 v[76:79], v[114:115], v[14:15], 0
    v_cvt_pk_bf16_f32 v48, v48, v49
    v_cvt_pk_bf16_f32 v49, v50, v51
    v_cvt_pk_bf16_f32 v50, v52, v53
    v_cvt_pk_bf16_f32 v51, v54, v55
    v_cvt_pk_bf16_f32 v52, v56, v57
    v_cvt_pk_bf16_f32 v53, v58, v59
    v_cvt_pk_bf16_f32 v54, v60, v61
    v_cvt_pk_bf16_f32 v55, v62, v63
    v_max3_f32 v16, v64, v65, v66
    v_max3_f32 v24, v72, v73, v74
    v_max3_f32 v17, -v64, -v65, -v66
    v_max3_f32 v25, -v72, -v73, -v74
    v_max3_f32 v18, v68, v69, v70
    v_max3_f32 v26, v76, v77, v78
    v_max3_f32 v19, -v68, -v69, -v70
    v_max3_f32 v27, -v76, -v77, -v78
    v_max_f32 v16, v16, v67
    v_max_f32 v24, v24, v75
    v_max_f32_e64 v17, v17, -v67
    v_max_f32_e64 v25, v25, -v75
    v_max_f32 v18, v18, v71
    v_max_f32 v26, v26, v79
    v_max_f32_e64 v19, v19, -v71
    v_max_f32_e64 v27, v27, -v79
    v_permlane32_swap_b32 v16, v17
    v_permlane32_swap_b32 v24, v25
    v_permlane32_swap_b32 v18, v19
    v_permlane32_swap_b32 v26, v27
    v_max_f32 v16, v16, v17
    v_max_f32 v24, v24, v25
    v_max_f32 v18, v18, v19
    v_max_f32 v26, v26, v27
    s_nop 0
    v_permlane16_swap_b32 v16, v18
    v_permlane16_swap_b32 v24, v26
    v_max_f32 v16, v16, v18
    v_max_f32 v24, v24, v26
    v_mul_f32 v16, v118, v16
    v_mul_f32 v24, v118, v24
    v_mov_b32 v18, v16
    v_mov_b32 v26, v24
    s_nop 0
    v_permlane16_swap_b32 v16, v18
    v_permlane16_swap_b32 v24, v26
    v_mov_b32 v17, v16
    v_mov_b32 v25, v24
    v_mov_b32 v19, v18
    v_mov_b32 v27, v26
    v_permlane32_swap_b32 v16, v17
    v_permlane32_swap_b32 v24, v25
    v_permlane32_swap_b32 v18, v19
    v_permlane32_swap_b32 v26, v27
    v_pk_fma_f32 v[80:81], v[64:65], v[118:119], v[16:17] op_sel:[0,0,0] op_sel_hi:[1,1,0] neg_lo:[0,0,1] neg_hi:[0,0,1]
    v_pk_fma_f32 v[88:89], v[72:73], v[118:119], v[24:25] op_sel:[0,0,0] op_sel_hi:[1,1,0] neg_lo:[0,0,1] neg_hi:[0,0,1]
    v_pk_fma_f32 v[96:97], v[64:65], v[118:119], v[16:17] op_sel:[0,0,1] op_sel_hi:[1,1,1] neg_lo:[1,0,1] neg_hi:[1,0,1]
    v_pk_fma_f32 v[104:105], v[72:73], v[118:119], v[24:25] op_sel:[0,0,1] op_sel_hi:[1,1,1] neg_lo:[1,0,1] neg_hi:[1,0,1]
    v_pk_fma_f32 v[82:83], v[66:67], v[118:119], v[16:17] op_sel:[0,0,0] op_sel_hi:[1,1,0] neg_lo:[0,0,1] neg_hi:[0,0,1]
    v_pk_fma_f32 v[90:91], v[74:75], v[118:119], v[24:25] op_sel:[0,0,0] op_sel_hi:[1,1,0] neg_lo:[0,0,1] neg_hi:[0,0,1]
    v_pk_fma_f32 v[98:99], v[66:67], v[118:119], v[16:17] op_sel:[0,0,1] op_sel_hi:[1,1,1] neg_lo:[1,0,1] neg_hi:[1,0,1]
    v_pk_fma_f32 v[106:107], v[74:75], v[118:119], v[24:25] op_sel:[0,0,1] op_sel_hi:[1,1,1] neg_lo:[1,0,1] neg_hi:[1,0,1]
    v_pk_fma_f32 v[84:85], v[68:69], v[118:119], v[18:19] op_sel:[0,0,0] op_sel_hi:[1,1,0] neg_lo:[0,0,1] neg_hi:[0,0,1]
    v_pk_fma_f32 v[92:93], v[76:77], v[118:119], v[26:27] op_sel:[0,0,0] op_sel_hi:[1,1,0] neg_lo:[0,0,1] neg_hi:[0,0,1]
    v_pk_fma_f32 v[100:101], v[68:69], v[118:119], v[18:19] op_sel:[0,0,1] op_sel_hi:[1,1,1] neg_lo:[1,0,1] neg_hi:[1,0,1]
    v_pk_fma_f32 v[108:109], v[76:77], v[118:119], v[26:27] op_sel:[0,0,1] op_sel_hi:[1,1,1] neg_lo:[1,0,1] neg_hi:[1,0,1]
    v_pk_fma_f32 v[86:87], v[70:71], v[118:119], v[18:19] op_sel:[0,0,0] op_sel_hi:[1,1,0] neg_lo:[0,0,1] neg_hi:[0,0,1]
    v_pk_fma_f32 v[94:95], v[78:79], v[118:119], v[26:27] op_sel:[0,0,0] op_sel_hi:[1,1,0] neg_lo:[0,0,1] neg_hi:[0,0,1]
    v_pk_fma_f32 v[102:103], v[70:71], v[118:119], v[18:19] op_sel:[0,0,1] op_sel_hi:[1,1,1] neg_lo:[1,0,1] neg_hi:[1,0,1]
    v_pk_fma_f32 v[110:111], v[78:79], v[118:119], v[26:27] op_sel:[0,0,1] op_sel_hi:[1,1,1] neg_lo:[1,0,1] neg_hi:[1,0,1]
    v_exp_f32 v80, v80
    v_exp_f32 v88, v88
    v_exp_f32 v96, v96
    v_exp_f32 v104, v104
    v_exp_f32 v81, v81
    v_exp_f32 v89, v89
    v_exp_f32 v97, v97
    v_exp_f32 v105, v105
    v_exp_f32 v82, v82
    v_exp_f32 v90, v90
    v_exp_f32 v98, v98
    v_exp_f32 v106, v106
    v_exp_f32 v83, v83
    v_exp_f32 v91, v91
    v_exp_f32 v99, v99
    v_exp_f32 v107, v107
    v_exp_f32 v84, v84
    v_exp_f32 v92, v92
    v_exp_f32 v100, v100
    v_exp_f32 v108, v108
    v_exp_f32 v85, v85
    v_exp_f32 v93, v93
    v_exp_f32 v101, v101
    v_exp_f32 v109, v109
    v_exp_f32 v86, v86
    v_exp_f32 v94, v94
    v_exp_f32 v102, v102
    v_exp_f32 v110, v110
    v_exp_f32 v87, v87
    v_exp_f32 v95, v95
    v_exp_f32 v103, v103
    v_exp_f32 v111, v111
    v_pk_add_f32 v[20:21], v[80:81], v[82:83]
    v_pk_add_f32 v[28:29], v[88:89], v[90:91]
    v_pk_add_f32 v[22:23], v[96:97], v[98:99]
    v_pk_add_f32 v[30:31], v[104:105], v[106:107]
    v_add_f32 v16, v20, v21
    v_add_f32 v24, v28, v29
    v_add_f32 v17, v22, v23
    v_add_f32 v25, v30, v31
    v_pk_add_f32 v[20:21], v[84:85], v[86:87]
    v_pk_add_f32 v[28:29], v[92:93], v[94:95]
    v_pk_add_f32 v[22:23], v[100:101], v[102:103]
    v_pk_add_f32 v[30:31], v[108:109], v[110:111]
    v_add_f32 v18, v20, v21
    v_add_f32 v26, v28, v29
    v_add_f32 v19, v22, v23
    v_add_f32 v27, v30, v31
    v_permlane32_swap_b32 v16, v17
    v_permlane32_swap_b32 v24, v25
    v_permlane32_swap_b32 v18, v19
    v_permlane32_swap_b32 v26, v27
    v_add_f32 v16, v16, v17
    v_add_f32 v24, v24, v25
    v_add_f32 v18, v18, v19
    v_add_f32 v26, v26, v27
    s_nop 0
    v_permlane16_swap_b32 v16, v18
    v_permlane16_swap_b32 v24, v26
    v_add_f32 v16, v16, v18
    v_add_f32 v24, v24, v26
    v_rcp_f32 v16, v16
    v_rcp_f32 v24, v24
    v_mov_b32 v18, v16
    v_mov_b32 v26, v24
    s_nop 0
    v_permlane16_swap_b32 v16, v18
    v_permlane16_swap_b32 v24, v26
    v_mov_b32 v17, v16
    v_mov_b32 v25, v24
    v_mov_b32 v19, v18
    v_mov_b32 v27, v26
    v_permlane32_swap_b32 v16, v17
    v_permlane32_swap_b32 v24, v25
    v_permlane32_swap_b32 v18, v19
    v_permlane32_swap_b32 v26, v27
    v_pk_mul_f32 v[80:81], v[80:81], v[16:17] op_sel:[0,0] op_sel_hi:[1,0]
    v_pk_mul_f32 v[88:89], v[88:89], v[24:25] op_sel:[0,0] op_sel_hi:[1,0]
    v_pk_mul_f32 v[96:97], v[96:97], v[16:17] op_sel:[0,1] op_sel_hi:[1,1]
    v_pk_mul_f32 v[104:105], v[104:105], v[24:25] op_sel:[0,1] op_sel_hi:[1,1]
    v_pk_mul_f32 v[82:83], v[82:83], v[16:17] op_sel:[0,0] op_sel_hi:[1,0]
    v_pk_mul_f32 v[90:91], v[90:91], v[24:25] op_sel:[0,0] op_sel_hi:[1,0]
    v_pk_mul_f32 v[98:99], v[98:99], v[16:17] op_sel:[0,1] op_sel_hi:[1,1]
    v_pk_mul_f32 v[106:107], v[106:107], v[24:25] op_sel:[0,1] op_sel_hi:[1,1]
    v_pk_mul_f32 v[84:85], v[84:85], v[18:19] op_sel:[0,0] op_sel_hi:[1,0]
    v_pk_mul_f32 v[92:93], v[92:93], v[26:27] op_sel:[0,0] op_sel_hi:[1,0]
    v_pk_mul_f32 v[100:101], v[100:101], v[18:19] op_sel:[0,1] op_sel_hi:[1,1]
    v_pk_mul_f32 v[108:109], v[108:109], v[26:27] op_sel:[0,1] op_sel_hi:[1,1]
    v_pk_mul_f32 v[86:87], v[86:87], v[18:19] op_sel:[0,0] op_sel_hi:[1,0]
    v_pk_mul_f32 v[94:95], v[94:95], v[26:27] op_sel:[0,0] op_sel_hi:[1,0]
    v_pk_mul_f32 v[102:103], v[102:103], v[18:19] op_sel:[0,1] op_sel_hi:[1,1]
    v_pk_mul_f32 v[110:111], v[110:111], v[26:27] op_sel:[0,1] op_sel_hi:[1,1]
    v_cvt_pk_bf16_f32 v32, v80, v81
    v_cvt_pk_bf16_f32 v40, v88, v89
    v_cvt_pk_bf16_f32 v34, v96, v97
    v_cvt_pk_bf16_f32 v42, v104, v105
    v_cvt_pk_bf16_f32 v33, v82, v83
    v_cvt_pk_bf16_f32 v41, v90, v91
    v_cvt_pk_bf16_f32 v35, v98, v99
    v_cvt_pk_bf16_f32 v43, v106, v107
    v_cvt_pk_bf16_f32 v36, v84, v85
    v_cvt_pk_bf16_f32 v44, v92, v93
    v_cvt_pk_bf16_f32 v38, v100, v101
    v_cvt_pk_bf16_f32 v46, v108, v109
    v_cvt_pk_bf16_f32 v37, v86, v87
    v_cvt_pk_bf16_f32 v45, v94, v95
    v_cvt_pk_bf16_f32 v39, v102, v103
    v_cvt_pk_bf16_f32 v47, v110, v111
    v_mfma_f32_16x16x16_bf16 v[64:67], v[32:33], v[116:117], 0
    v_mfma_f32_16x16x16_bf16 v[68:71], v[36:37], v[116:117], 0
    v_mfma_f32_16x16x16_bf16 v[72:75], v[34:35], v[116:117], 0
    v_mfma_f32_16x16x16_bf16 v[76:79], v[38:39], v[116:117], 0
    v_mfma_f32_16x16x16_bf16 v[80:83], v[40:41], v[116:117], 0
    v_mfma_f32_16x16x16_bf16 v[84:87], v[44:45], v[116:117], 0
    v_mfma_f32_16x16x16_bf16 v[88:91], v[42:43], v[116:117], 0
    v_mfma_f32_16x16x16_bf16 v[92:95], v[46:47], v[116:117], 0
    s_nop 0
    v_cvt_pk_bf16_f32 v96, v64, v65
    v_cvt_pk_bf16_f32 v97, v66, v67
    v_cvt_pk_bf16_f32 v98, v68, v69
    v_cvt_pk_bf16_f32 v99, v70, v71
    v_cvt_pk_bf16_f32 v100, v72, v73
    v_cvt_pk_bf16_f32 v101, v74, v75
    v_cvt_pk_bf16_f32 v102, v76, v77
    v_cvt_pk_bf16_f32 v103, v78, v79
    v_cvt_pk_bf16_f32 v104, v80, v81
    v_cvt_pk_bf16_f32 v105, v82, v83
    v_cvt_pk_bf16_f32 v106, v84, v85
    v_cvt_pk_bf16_f32 v107, v86, v87
    v_cvt_pk_bf16_f32 v108, v88, v89
    v_cvt_pk_bf16_f32 v109, v90, v91
    v_cvt_pk_bf16_f32 v110, v92, v93
    v_cvt_pk_bf16_f32 v111, v94, v95
    v_mfma_f32_16x16x32_bf16 v[16:19], v[96:99], v[48:51], 0
    v_mfma_f32_16x16x32_bf16 v[20:23], v[100:103], v[48:51], 0
    v_mfma_f32_16x16x32_bf16 v[24:27], v[104:107], v[52:55], 0
    v_mfma_f32_16x16x32_bf16 v[28:31], v[108:111], v[52:55], 0
    v_mfma_f32_16x16x32_bf16 v[32:35], v[96:99], v[120:123], 0
    v_mfma_f32_16x16x32_bf16 v[36:39], v[100:103], v[120:123], 0
    v_mfma_f32_16x16x32_bf16 v[40:43], v[104:107], v[120:123], 0
    v_mfma_f32_16x16x32_bf16 v[44:47], v[108:111], v[120:123], 0
    s_nop 0
    ds_write_b128 v2, v[16:19] offset:0
    ds_write_b128 v2, v[20:23] offset:1024
    ds_write_b128 v2, v[24:27] offset:2048
    ds_write_b128 v2, v[28:31] offset:3072
    ds_write_b128 v3, v[32:35] offset:4096
    ds_write_b128 v3, v[36:39] offset:4160
    ds_write_b128 v3, v[40:43] offset:4224
    ds_write_b128 v3, v[44:47] offset:4288
    v_mov_b32 v8, 5
    ds_write_b32 v7, v8
    s_lshl_b32 s59, s53, 10
    s_add_u32 s59, s59, 135168
    v_add_u32 v10, s59, v1
    v_and_b32 v11, 3, v0
    v_and_b32 v9, 48, v0
    v_lshl_add_u32 v11, v11, 2, v9
    s_lshl_b32 s59, s53, 6
    s_add_u32 s59, s59, 139264
    v_add_u32 v11, s59, v11
    s_mov_b32 s63, 2097152
L_lw_15:
    ds_read_b32 v9, v4 offset:0
    ds_read_b128 v[64:67], v10 offset:0
    ds_read_b128 v[68:71], v10 offset:4352
    ds_read_b128 v[72:75], v10 offset:8704
    ds_read_b128 v[76:79], v10 offset:13056
    ds_read_b32 v80, v11 offset:0
    ds_read_b32 v81, v11 offset:4352
    ds_read_b32 v82, v11 offset:8704
    ds_read_b32 v83, v11 offset:13056
    s_sub_u32 s63, s63, 1
    s_cbranch_scc1 L_lwd_16
    s_waitcnt lgkmcnt(8)
    v_cmp_gt_u32 vcc, 5, v9
    s_nop 0
    s_cbranch_vccnz L_lw_15
L_lwd_16:
    v_add_u32 v124, 65536, v124
    v_add_u32 v125, 65536, v125
    v_mov_b32 v15, v127
    s_waitcnt lgkmcnt(4)
    v_pk_add_f32 v[64:65], v[64:65], v[68:69]
    v_pk_add_f32 v[72:73], v[72:73], v[76:77]
    v_pk_add_f32 v[66:67], v[66:67], v[70:71]
    v_pk_add_f32 v[74:75], v[74:75], v[78:79]
    v_pk_add_f32 v[64:65], v[64:65], v[72:73]
    v_pk_add_f32 v[66:67], v[66:67], v[74:75]
    s_waitcnt lgkmcnt(0)
    v_pk_add_f32 v[80:81], v[80:81], v[82:83]
    v_cvt_pk_bf16_f32 v12, v64, v65
    v_cvt_pk_bf16_f32 v13, v66, v67
    v_add_f32 v14, v80, v81
    buffer_store_dwordx4 v[12:15], v1, s[12:15], s77 offen sc1
    v_mov_b32 v9, 6
    ds_write_b32 v7, v9
    s_lshl2_add_u32 s59, s55, s53
    s_lshl_b32 s60, s54, 6
    s_lshl_b32 s16, s59, 14
    s_add_u32 s16, s16, s60
    s_add_u32 s16, s16, 0x40000
    s_lshl_b32 s17, s59, 10
    s_add_u32 s17, s17, s60
    s_add_u32 s17, s17, 0x30000
    s_lshl_b32 s18, s55, 12
    s_add_u32 s18, s18, 0x30000
    v_lshrrev_b32 v48, 2, v0
    v_lshlrev_b32 v48, 10, v48
    v_and_b32 v49, 3, v0
    v_lshl_add_u32 v48, v49, 4, v48
    s_lshl_b32 s59, s53, 7
    s_add_u32 s60, s59, s55
    s_lshl_b32 s66, s60, 10
    s_add_u32 s66, s66, s57
    s_add_u32 s66, s66, 0x8000
    s_add_u32 s67, s66, 16384
    s_add_u32 s59, s59, s57
    s_add_u32 s75, s59, 0x80400
    s_lshl2_add_u32 s59, s55, s59
    s_add_u32 s68, s59, 0x80200
    s_add_u32 s76, s59, 0x80600
    s_lshr_b32 s60, s55, 3
    s_lshl2_add_u32 s60, s60, s53
    s_and_b32 s61, s55, 7
    s_lshr_b32 s64, s60, 1
    s_lshl_b32 s59, s64, 7
    s_add_u32 s59, s59, s57
    s_add_u32 s69, s59, 0x80200
    s_add_u32 s77, s59, 0x80600
    s_and_b32 s52, s53, 1
    s_lshl3_add_u32 s62, s52, s61
    s_lshl2_add_u32 s59, s62, s59
    s_add_u32 s74, s59, 0x80400
    s_lshl_b32 s59, s60, 11
    s_add_u32 s59, s59, s57
    s_add_u32 s72, s59, 0x81000
    s_lshl_b32 s59, s61, 8
    s_add_u32 s73, s72, s59
    s_lshl_b32 s64, s64, 17
    s_add_u32 s64, s64, s57
    s_lshl_b32 s59, s62, 11
    s_add_u32 s71, s64, s59
    s_add_u32 s64, s64, 0x8000
    s_lshl_b32 s59, s52, 14
    s_add_u32 s70, s64, s59
    s_mul_i32 s59, s52, 49152
    s_add_u32 s64, s64, s59
    s_and_b32 s54, s54, 14
    s_cmp_eq_u32 s54, 14
    s_cselect_b32 s65, 0, s54
    v_lshrrev_b32 v2, 2, v0
    v_lshlrev_b32 v2, 7, v2
    v_and_b32 v3, 3, v0
    v_lshl_add_u32 v2, v3, 3, v2
    v_bfe_u32 v3, v0, 3, 2
    v_lshl_add_u32 v120, v3, 5, v2
    v_xor_b32 v121, 32, v120
    v_xor_b32 v122, 64, v120
    v_xor_b32 v123, 96, v120
    s_mov_b32 s63, 2097152
L_lw_17:
    ds_read_b32 v9, v4 offset:16
    s_sub_u32 s63, s63, 1
    s_cbranch_scc1 L_lwd_18
    s_waitcnt lgkmcnt(0)
    v_cmp_gt_u32 vcc, 3, v9
    s_nop 0
    s_cbranch_vccz L_lwd_18
    s_sleep 1
    s_branch L_lw_17
L_lwd_18:
    ds_read_b64_tr_b16 v[64:65], v124 offset:0
    ds_read_b64_tr_b16 v[66:67], v124 offset:256
    ds_read_b64_tr_b16 v[68:69], v125 offset:0
    ds_read_b64_tr_b16 v[70:71], v125 offset:256
    ds_read_b64_tr_b16 v[72:73], v124 offset:2048
    ds_read_b64_tr_b16 v[74:75], v124 offset:2304
    ds_read_b64_tr_b16 v[76:77], v125 offset:2048
    ds_read_b64_tr_b16 v[78:79], v125 offset:2304
    ds_read_b64_tr_b16 v[80:81], v124 offset:4096
    ds_read_b64_tr_b16 v[82:83], v124 offset:4352
    ds_read_b64_tr_b16 v[84:85], v125 offset:4096
    ds_read_b64_tr_b16 v[86:87], v125 offset:4352
    s_waitcnt lgkmcnt(8)
    v_mfma_f32_16x16x32_bf16 v[32:35], v[64:67], a[0:3], 0
    ds_read_b64_tr_b16 v[88:89], v124 offset:6144
    v_mfma_f32_16x16x32_bf16 v[36:39], v[68:71], a[0:3], 0
    ds_read_b64_tr_b16 v[90:91], v124 offset:6400
    v_mfma_f32_16x16x32_bf16 v[40:43], v[64:67], a[4:7], 0
    ds_read_b64_tr_b16 v[92:93], v125 offset:6144
    v_mfma_f32_16x16x32_bf16 v[44:47], v[68:71], a[4:7], 0
    ds_read_b64_tr_b16 v[94:95], v125 offset:6400
    s_waitcnt lgkmcnt(8)
    v_mfma_f32_16x16x32_bf16 v[32:35], v[72:75], a[8:11], v[32:35]
    ds_read_b64_tr_b16 v[64:65], v124 offset:8192
    v_mfma_f32_16x16x32_bf16 v[36:39], v[76:79], a[8:11], v[36:39]
    ds_read_b64_tr_b16 v[66:67], v124 offset:8448
    v_mfma_f32_16x16x32_bf16 v[40:43], v[72:75], a[12:15], v[40:43]
    ds_read_b64_tr_b16 v[68:69], v125 offset:8192
    v_mfma_f32_16x16x32_bf16 v[44:47], v[76:79], a[12:15], v[44:47]
    ds_read_b64_tr_b16 v[70:71], v125 offset:8448
    s_waitcnt lgkmcnt(8)
    v_mfma_f32_16x16x32_bf16 v[32:35], v[80:83], a[16:19], v[32:35]
    ds_read_b64_tr_b16 v[72:73], v124 offset:10240
    v_mfma_f32_16x16x32_bf16 v[36:39], v[84:87], a[16:19], v[36:39]
    ds_read_b64_tr_b16 v[74:75], v124 offset:10496
    v_mfma_f32_16x16x32_bf16 v[40:43], v[80:83], a[20:23], v[40:43]
    ds_read_b64_tr_b16 v[76:77], v125 offset:10240
    v_mfma_f32_16x16x32_bf16 v[44:47], v[84:87], a[20:23], v[44:47]
    ds_read_b64_tr_b16 v[78:79], v125 offset:10496
    s_waitcnt lgkmcnt(8)
    v_mfma_f32_16x16x32_bf16 v[32:35], v[88:91], a[24:27], v[32:35]
    ds_read_b64_tr_b16 v[80:81], v124 offset:12288
    v_mfma_f32_16x16x32_bf16 v[36:39], v[92:95], a[24:27], v[36:39]
    ds_read_b64_tr_b16 v[82:83], v124 offset:12544
    v_mfma_f32_16x16x32_bf16 v[40:43], v[88:91], a[28:31], v[40:43]
    ds_read_b64_tr_b16 v[84:85], v125 offset:12288
    v_mfma_f32_16x16x32_bf16 v[44:47], v[92:95], a[28:31], v[44:47]
    ds_read_b64_tr_b16 v[86:87], v125 offset:12544
    s_waitcnt lgkmcnt(8)
    v_mfma_f32_16x16x32_bf16 v[32:35], v[64:67], a[32:35], v[32:35]
    ds_read_b64_tr_b16 v[88:89], v124 offset:14336
    v_mfma_f32_16x16x32_bf16 v[36:39], v[68:71], a[32:35], v[36:39]
    ds_read_b64_tr_b16 v[90:91], v124 offset:14592
    v_mfma_f32_16x16x32_bf16 v[40:43], v[64:67], a[36:39], v[40:43]
    ds_read_b64_tr_b16 v[92:93], v125 offset:14336
    v_mfma_f32_16x16x32_bf16 v[44:47], v[68:71], a[36:39], v[44:47]
    ds_read_b64_tr_b16 v[94:95], v125 offset:14592
    s_waitcnt lgkmcnt(8)
    v_mfma_f32_16x16x32_bf16 v[32:35], v[72:75], a[40:43], v[32:35]
    ds_read_b64_tr_b16 v[64:65], v124 offset:16384
    v_mfma_f32_16x16x32_bf16 v[36:39], v[76:79], a[40:43], v[36:39]
    ds_read_b64_tr_b16 v[66:67], v124 offset:16640
    v_mfma_f32_16x16x32_bf16 v[40:43], v[72:75], a[44:47], v[40:43]
    ds_read_b64_tr_b16 v[68:69], v125 offset:16384
    v_mfma_f32_16x16x32_bf16 v[44:47], v[76:79], a[44:47], v[44:47]
    ds_read_b64_tr_b16 v[70:71], v125 offset:16640
    s_waitcnt lgkmcnt(8)
    v_mfma_f32_16x16x32_bf16 v[32:35], v[80:83], a[48:51], v[32:35]
    ds_read_b64_tr_b16 v[72:73], v124 offset:18432
    v_mfma_f32_16x16x32_bf16 v[36:39], v[84:87], a[48:51], v[36:39]
    ds_read_b64_tr_b16 v[74:75], v124 offset:18688
    v_mfma_f32_16x16x32_bf16 v[40:43], v[80:83], a[52:55], v[40:43]
    ds_read_b64_tr_b16 v[76:77], v125 offset:18432
    v_mfma_f32_16x16x32_bf16 v[44:47], v[84:87], a[52:55], v[44:47]
    ds_read_b64_tr_b16 v[78:79], v125 offset:18688
    s_waitcnt lgkmcnt(8)
    v_mfma_f32_16x16x32_bf16 v[32:35], v[88:91], a[56:59], v[32:35]
    ds_read_b64_tr_b16 v[80:81], v124 offset:20480
    v_mfma_f32_16x16x32_bf16 v[36:39], v[92:95], a[56:59], v[36:39]
    ds_read_b64_tr_b16 v[82:83], v124 offset:20736
    v_mfma_f32_16x16x32_bf16 v[40:43], v[88:91], a[60:63], v[40:43]
    ds_read_b64_tr_b16 v[84:85], v125 offset:20480
    v_mfma_f32_16x16x32_bf16 v[44:47], v[92:95], a[60:63], v[44:47]
    ds_read_b64_tr_b16 v[86:87], v125 offset:20736
    s_waitcnt lgkmcnt(8)
    v_mfma_f32_16x16x32_bf16 v[32:35], v[64:67], a[64:67], v[32:35]
    ds_read_b64_tr_b16 v[88:89], v124 offset:22528
    v_mfma_f32_16x16x32_bf16 v[36:39], v[68:71], a[64:67], v[36:39]
    ds_read_b64_tr_b16 v[90:91], v124 offset:22784
    v_mfma_f32_16x16x32_bf16 v[40:43], v[64:67], a[68:71], v[40:43]
    ds_read_b64_tr_b16 v[92:93], v125 offset:22528
    v_mfma_f32_16x16x32_bf16 v[44:47], v[68:71], a[68:71], v[44:47]
    ds_read_b64_tr_b16 v[94:95], v125 offset:22784
    s_waitcnt lgkmcnt(8)
    v_mfma_f32_16x16x32_bf16 v[32:35], v[72:75], a[72:75], v[32:35]
    ds_read_b64_tr_b16 v[64:65], v124 offset:24576
    v_mfma_f32_16x16x32_bf16 v[36:39], v[76:79], a[72:75], v[36:39]
    ds_read_b64_tr_b16 v[66:67], v124 offset:24832
    v_mfma_f32_16x16x32_bf16 v[40:43], v[72:75], a[76:79], v[40:43]
    ds_read_b64_tr_b16 v[68:69], v125 offset:24576
    v_mfma_f32_16x16x32_bf16 v[44:47], v[76:79], a[76:79], v[44:47]
    ds_read_b64_tr_b16 v[70:71], v125 offset:24832
    s_waitcnt lgkmcnt(8)
    v_mfma_f32_16x16x32_bf16 v[32:35], v[80:83], a[80:83], v[32:35]
    ds_read_b64_tr_b16 v[72:73], v124 offset:26624
    v_mfma_f32_16x16x32_bf16 v[36:39], v[84:87], a[80:83], v[36:39]
    ds_read_b64_tr_b16 v[74:75], v124 offset:26880
    v_mfma_f32_16x16x32_bf16 v[40:43], v[80:83], a[84:87], v[40:43]
    ds_read_b64_tr_b16 v[76:77], v125 offset:26624
    v_mfma_f32_16x16x32_bf16 v[44:47], v[84:87], a[84:87], v[44:47]
    ds_read_b64_tr_b16 v[78:79], v125 offset:26880
    s_waitcnt lgkmcnt(8)
    v_mfma_f32_16x16x32_bf16 v[32:35], v[88:91], a[88:91], v[32:35]
    ds_read_b64_tr_b16 v[80:81], v124 offset:28672
    v_mfma_f32_16x16x32_bf16 v[36:39], v[92:95], a[88:91], v[36:39]
    ds_read_b64_tr_b16 v[82:83], v124 offset:28928
    v_mfma_f32_16x16x32_bf16 v[40:43], v[88:91], a[92:95], v[40:43]
    ds_read_b64_tr_b16 v[84:85], v125 offset:28672
    v_mfma_f32_16x16x32_bf16 v[44:47], v[92:95], a[92:95], v[44:47]
    ds_read_b64_tr_b16 v[86:87], v125 offset:28928
    s_waitcnt lgkmcnt(8)
    v_mfma_f32_16x16x32_bf16 v[32:35], v[64:67], a[96:99], v[32:35]
    ds_read_b64_tr_b16 v[88:89], v124 offset:30720
    v_mfma_f32_16x16x32_bf16 v[36:39], v[68:71], a[96:99], v[36:39]
    ds_read_b64_tr_b16 v[90:91], v124 offset:30976
    v_mfma_f32_16x16x32_bf16 v[40:43], v[64:67], a[100:103], v[40:43]
    ds_read_b64_tr_b16 v[92:93], v125 offset:30720
    v_mfma_f32_16x16x32_bf16 v[44:47], v[68:71], a[100:103], v[44:47]
    ds_read_b64_tr_b16 v[94:95], v125 offset:30976
    s_waitcnt lgkmcnt(8)
    v_mfma_f32_16x16x32_bf16 v[32:35], v[72:75], a[104:107], v[32:35]
    v_mfma_f32_16x16x32_bf16 v[36:39], v[76:79], a[104:107], v[36:39]
    v_mfma_f32_16x16x32_bf16 v[40:43], v[72:75], a[108:111], v[40:43]
    v_mfma_f32_16x16x32_bf16 v[44:47], v[76:79], a[108:111], v[44:47]
    s_waitcnt lgkmcnt(4)
    v_mfma_f32_16x16x32_bf16 v[32:35], v[80:83], a[112:115], v[32:35]
    v_mfma_f32_16x16x32_bf16 v[36:39], v[84:87], a[112:115], v[36:39]
    v_mfma_f32_16x16x32_bf16 v[40:43], v[80:83], a[116:119], v[40:43]
    v_mfma_f32_16x16x32_bf16 v[44:47], v[84:87], a[116:119], v[44:47]
    s_waitcnt lgkmcnt(0)
    v_mfma_f32_16x16x32_bf16 v[32:35], v[88:91], a[120:123], v[32:35]
    v_mfma_f32_16x16x32_bf16 v[36:39], v[92:95], a[120:123], v[36:39]
    v_mfma_f32_16x16x32_bf16 v[40:43], v[88:91], a[124:127], v[40:43]
    v_mfma_f32_16x16x32_bf16 v[44:47], v[92:95], a[124:127], v[44:47]
    s_nop 4
    v_cvt_pk_bf16_f32 v8, v32, v33
    v_cvt_pk_bf16_f32 v9, v34, v35
    v_cvt_pk_bf16_f32 v10, v36, v37
    v_cvt_pk_bf16_f32 v11, v38, v39
    v_cvt_pk_bf16_f32 v12, v40, v41
    v_cvt_pk_bf16_f32 v13, v42, v43
    v_cvt_pk_bf16_f32 v14, v44, v45
    v_cvt_pk_bf16_f32 v15, v46, v47
    v_mfma_f32_16x16x16_bf16 v[64:67], v[112:113], v[8:9], 0
    v_mfma_f32_16x16x16_bf16 v[68:71], v[114:115], v[10:11], 0
    v_mfma_f32_16x16x16_bf16 v[72:75], v[112:113], v[12:13], 0
    v_mfma_f32_16x16x16_bf16 v[76:79], v[114:115], v[14:15], 0
    s_mov_b32 s63, 262144
L_h1p:
    buffer_load_dwordx4 v[8:11], v48, s[12:15], s16 offen sc1
    s_sub_u32 s63, s63, 1
    s_cbranch_scc1 L_h1d
    s_waitcnt vmcnt(0)
    v_cmp_ne_u32 vcc, s56, v11
    s_nop 0
    s_cbranch_vccnz L_h1p
L_h1d:
    s_waitcnt vmcnt(0)
    v_lshlrev_b32 v12, 16, v8
    v_lshlrev_b32 v14, 16, v9
    v_and_b32 v13, v126, v8
    v_and_b32 v15, v126, v9
    v_permlane32_swap_b32 v12, v14
    v_mov_b32 v16, v10
    v_permlane32_swap_b32 v13, v15
    s_nop 0
    v_permlane32_swap_b32 v10, v16
    v_add_f32 v12, v12, v14
    v_add_f32 v10, v10, v16
    v_add_f32 v13, v13, v15
    v_mov_b32 v16, v10
    s_nop 0
    v_permlane16_swap_b32 v12, v13
    v_permlane16_swap_b32 v10, v16
    v_add_f32 v12, v12, v13
    v_add_f32 v10, v10, v16
    s_nop 0
    v_add_f32_dpp v13, v12, v12 row_ror:4 row_mask:0xf bank_mask:0xf
    v_add_f32_dpp v16, v10, v10 row_ror:4 row_mask:0xf bank_mask:0xf
    s_nop 0
    v_add_f32_dpp v12, v13, v13 row_ror:8 row_mask:0xf bank_mask:0xf
    v_add_f32_dpp v10, v16, v16 row_ror:8 row_mask:0xf bank_mask:0xf
    v_mov_b32 v13, v12
    s_nop 0
    v_mov_b32_dpp v16, v10 quad_perm:[0,2,0,2] row_mask:0xf bank_mask:0xf
    v_permlane16_swap_b32 v12, v13
    v_mov_b32_dpp v17, v10 quad_perm:[1,3,1,3] row_mask:0xf bank_mask:0xf
    v_mov_b32 v14, v12
    v_cvt_pk_bf16_f32 v10, v16, v17
    v_mov_b32 v15, v13
    v_permlane32_swap_b32 v12, v14
    s_nop 0
    v_permlane32_swap_b32 v13, v15
    v_cvt_pk_bf16_f32 v8, v12, v13
    v_cvt_pk_bf16_f32 v9, v14, v15
    s_mov_b64 exec, 15
    buffer_store_dwordx4 v[8:11], v1, s[12:15], s17 offen sc1
    s_mov_b64 exec, -1
    v_mov_b32 v18, 7
    ds_write_b32 v7, v18
    v_max3_f32 v16, v64, v65, v66
    v_max3_f32 v24, v72, v73, v74
    v_max3_f32 v17, -v64, -v65, -v66
    v_max3_f32 v25, -v72, -v73, -v74
    v_max3_f32 v18, v68, v69, v70
    v_max3_f32 v26, v76, v77, v78
    v_max3_f32 v19, -v68, -v69, -v70
    v_max3_f32 v27, -v76, -v77, -v78
    v_max_f32 v16, v16, v67
    v_max_f32 v24, v24, v75
    v_max_f32_e64 v17, v17, -v67
    v_max_f32_e64 v25, v25, -v75
    v_max_f32 v18, v18, v71
    v_max_f32 v26, v26, v79
    v_max_f32_e64 v19, v19, -v71
    v_max_f32_e64 v27, v27, -v79
    v_permlane32_swap_b32 v16, v17
    v_permlane32_swap_b32 v24, v25
    v_permlane32_swap_b32 v18, v19
    v_permlane32_swap_b32 v26, v27
    v_max_f32 v16, v16, v17
    v_max_f32 v24, v24, v25
    v_max_f32 v18, v18, v19
    v_max_f32 v26, v26, v27
    s_nop 0
    v_permlane16_swap_b32 v16, v18
    v_permlane16_swap_b32 v24, v26
    v_max_f32 v16, v16, v18
    v_max_f32 v24, v24, v26
    v_mul_f32 v16, v118, v16
    v_mul_f32 v24, v118, v24
    v_mov_b32 v18, v16
    v_mov_b32 v26, v24
    s_nop 0
    v_permlane16_swap_b32 v16, v18
    v_permlane16_swap_b32 v24, v26
    v_mov_b32 v17, v16
    v_mov_b32 v25, v24
    v_mov_b32 v19, v18
    v_mov_b32 v27, v26
    v_permlane32_swap_b32 v16, v17
    v_permlane32_swap_b32 v24, v25
    v_permlane32_swap_b32 v18, v19
    v_permlane32_swap_b32 v26, v27
    v_pk_fma_f32 v[80:81], v[64:65], v[118:119], v[16:17] op_sel:[0,0,0] op_sel_hi:[1,1,0] neg_lo:[0,0,1] neg_hi:[0,0,1]
    v_pk_fma_f32 v[88:89], v[72:73], v[118:119], v[24:25] op_sel:[0,0,0] op_sel_hi:[1,1,0] neg_lo:[0,0,1] neg_hi:[0,0,1]
    v_pk_fma_f32 v[96:97], v[64:65], v[118:119], v[16:17] op_sel:[0,0,1] op_sel_hi:[1,1,1] neg_lo:[1,0,1] neg_hi:[1,0,1]
    v_pk_fma_f32 v[104:105], v[72:73], v[118:119], v[24:25] op_sel:[0,0,1] op_sel_hi:[1,1,1] neg_lo:[1,0,1] neg_hi:[1,0,1]
    v_pk_fma_f32 v[82:83], v[66:67], v[118:119], v[16:17] op_sel:[0,0,0] op_sel_hi:[1,1,0] neg_lo:[0,0,1] neg_hi:[0,0,1]
    v_pk_fma_f32 v[90:91], v[74:75], v[118:119], v[24:25] op_sel:[0,0,0] op_sel_hi:[1,1,0] neg_lo:[0,0,1] neg_hi:[0,0,1]
    v_pk_fma_f32 v[98:99], v[66:67], v[118:119], v[16:17] op_sel:[0,0,1] op_sel_hi:[1,1,1] neg_lo:[1,0,1] neg_hi:[1,0,1]
    v_pk_fma_f32 v[106:107], v[74:75], v[118:119], v[24:25] op_sel:[0,0,1] op_sel_hi:[1,1,1] neg_lo:[1,0,1] neg_hi:[1,0,1]
    v_pk_fma_f32 v[84:85], v[68:69], v[118:119], v[18:19] op_sel:[0,0,0] op_sel_hi:[1,1,0] neg_lo:[0,0,1] neg_hi:[0,0,1]
    v_pk_fma_f32 v[92:93], v[76:77], v[118:119], v[26:27] op_sel:[0,0,0] op_sel_hi:[1,1,0] neg_lo:[0,0,1] neg_hi:[0,0,1]
    v_pk_fma_f32 v[100:101], v[68:69], v[118:119], v[18:19] op_sel:[0,0,1] op_sel_hi:[1,1,1] neg_lo:[1,0,1] neg_hi:[1,0,1]
    v_pk_fma_f32 v[108:109], v[76:77], v[118:119], v[26:27] op_sel:[0,0,1] op_sel_hi:[1,1,1] neg_lo:[1,0,1] neg_hi:[1,0,1]
    v_pk_fma_f32 v[86:87], v[70:71], v[118:119], v[18:19] op_sel:[0,0,0] op_sel_hi:[1,1,0] neg_lo:[0,0,1] neg_hi:[0,0,1]
    v_pk_fma_f32 v[94:95], v[78:79], v[118:119], v[26:27] op_sel:[0,0,0] op_sel_hi:[1,1,0] neg_lo:[0,0,1] neg_hi:[0,0,1]
    v_pk_fma_f32 v[102:103], v[70:71], v[118:119], v[18:19] op_sel:[0,0,1] op_sel_hi:[1,1,1] neg_lo:[1,0,1] neg_hi:[1,0,1]
    v_pk_fma_f32 v[110:111], v[78:79], v[118:119], v[26:27] op_sel:[0,0,1] op_sel_hi:[1,1,1] neg_lo:[1,0,1] neg_hi:[1,0,1]
    v_exp_f32 v80, v80
    v_exp_f32 v88, v88
    v_exp_f32 v96, v96
    v_exp_f32 v104, v104
    v_exp_f32 v81, v81
    v_exp_f32 v89, v89
    v_exp_f32 v97, v97
    v_exp_f32 v105, v105
    v_exp_f32 v82, v82
    v_exp_f32 v90, v90
    v_exp_f32 v98, v98
    v_exp_f32 v106, v106
    v_exp_f32 v83, v83
    v_exp_f32 v91, v91
    v_exp_f32 v99, v99
    v_exp_f32 v107, v107
    v_exp_f32 v84, v84
    v_exp_f32 v92, v92
    v_exp_f32 v100, v100
    v_exp_f32 v108, v108
    v_exp_f32 v85, v85
    v_exp_f32 v93, v93
    v_exp_f32 v101, v101
    v_exp_f32 v109, v109
    v_exp_f32 v86, v86
    v_exp_f32 v94, v94
    v_exp_f32 v102, v102
    v_exp_f32 v110, v110
    v_exp_f32 v87, v87
    v_exp_f32 v95, v95
    v_exp_f32 v103, v103
    v_exp_f32 v111, v111
    v_pk_add_f32 v[20:21], v[80:81], v[82:83]
    v_pk_add_f32 v[28:29], v[88:89], v[90:91]
    v_pk_add_f32 v[22:23], v[96:97], v[98:99]
    v_pk_add_f32 v[30:31], v[104:105], v[106:107]
    v_add_f32 v16, v20, v21
    v_add_f32 v24, v28, v29
    v_add_f32 v17, v22, v23
    v_add_f32 v25, v30, v31
    v_pk_add_f32 v[20:21], v[84:85], v[86:87]
    v_pk_add_f32 v[28:29], v[92:93], v[94:95]
    v_pk_add_f32 v[22:23], v[100:101], v[102:103]
    v_pk_add_f32 v[30:31], v[108:109], v[110:111]
    v_add_f32 v18, v20, v21
    v_add_f32 v26, v28, v29
    v_add_f32 v19, v22, v23
    v_add_f32 v27, v30, v31
    v_permlane32_swap_b32 v16, v17
    v_permlane32_swap_b32 v24, v25
    v_permlane32_swap_b32 v18, v19
    v_permlane32_swap_b32 v26, v27
    v_add_f32 v16, v16, v17
    v_add_f32 v24, v24, v25
    v_add_f32 v18, v18, v19
    v_add_f32 v26, v26, v27
    s_nop 0
    v_permlane16_swap_b32 v16, v18
    v_permlane16_swap_b32 v24, v26
    v_add_f32 v16, v16, v18
    v_add_f32 v24, v24, v26
    v_rcp_f32 v16, v16
    v_rcp_f32 v24, v24
    v_mov_b32 v18, v16
    v_mov_b32 v26, v24
    s_nop 0
    v_permlane16_swap_b32 v16, v18
    v_permlane16_swap_b32 v24, v26
    v_mov_b32 v17, v16
    v_mov_b32 v25, v24
    v_mov_b32 v19, v18
    v_mov_b32 v27, v26
    v_permlane32_swap_b32 v16, v17
    v_permlane32_swap_b32 v24, v25
    v_permlane32_swap_b32 v18, v19
    v_permlane32_swap_b32 v26, v27
    v_pk_mul_f32 v[80:81], v[80:81], v[16:17] op_sel:[0,0] op_sel_hi:[1,0]
    v_pk_mul_f32 v[88:89], v[88:89], v[24:25] op_sel:[0,0] op_sel_hi:[1,0]
    v_pk_mul_f32 v[96:97], v[96:97], v[16:17] op_sel:[0,1] op_sel_hi:[1,1]
    v_pk_mul_f32 v[104:105], v[104:105], v[24:25] op_sel:[0,1] op_sel_hi:[1,1]
    v_pk_mul_f32 v[82:83], v[82:83], v[16:17] op_sel:[0,0] op_sel_hi:[1,0]
    v_pk_mul_f32 v[90:91], v[90:91], v[24:25] op_sel:[0,0] op_sel_hi:[1,0]
    v_pk_mul_f32 v[98:99], v[98:99], v[16:17] op_sel:[0,1] op_sel_hi:[1,1]
    v_pk_mul_f32 v[106:107], v[106:107], v[24:25] op_sel:[0,1] op_sel_hi:[1,1]
    v_pk_mul_f32 v[84:85], v[84:85], v[18:19] op_sel:[0,0] op_sel_hi:[1,0]
    v_pk_mul_f32 v[92:93], v[92:93], v[26:27] op_sel:[0,0] op_sel_hi:[1,0]
    v_pk_mul_f32 v[100:101], v[100:101], v[18:19] op_sel:[0,1] op_sel_hi:[1,1]
    v_pk_mul_f32 v[108:109], v[108:109], v[26:27] op_sel:[0,1] op_sel_hi:[1,1]
    v_pk_mul_f32 v[86:87], v[86:87], v[18:19] op_sel:[0,0] op_sel_hi:[1,0]
    v_pk_mul_f32 v[94:95], v[94:95], v[26:27] op_sel:[0,0] op_sel_hi:[1,0]
    v_pk_mul_f32 v[102:103], v[102:103], v[18:19] op_sel:[0,1] op_sel_hi:[1,1]
    v_pk_mul_f32 v[110:111], v[110:111], v[26:27] op_sel:[0,1] op_sel_hi:[1,1]
    v_cvt_pk_bf16_f32 v32, v80, v81
    v_cvt_pk_bf16_f32 v40, v88, v89
    v_cvt_pk_bf16_f32 v34, v96, v97
    v_cvt_pk_bf16_f32 v42, v104, v105
    v_cvt_pk_bf16_f32 v33, v82, v83
    v_cvt_pk_bf16_f32 v41, v90, v91
    v_cvt_pk_bf16_f32 v35, v98, v99
    v_cvt_pk_bf16_f32 v43, v106, v107
    v_cvt_pk_bf16_f32 v36, v84, v85
    v_cvt_pk_bf16_f32 v44, v92, v93
    v_cvt_pk_bf16_f32 v38, v100, v101
    v_cvt_pk_bf16_f32 v46, v108, v109
    v_cvt_pk_bf16_f32 v37, v86, v87
    v_cvt_pk_bf16_f32 v45, v94, v95
    v_cvt_pk_bf16_f32 v39, v102, v103
    v_cvt_pk_bf16_f32 v47, v110, v111
    s_mov_b32 s63, 262144
    s_branch L_h2f
L_h2p:
    s_sleep 2
L_h2f:
    buffer_load_dwordx4 v[16:19], v1, s[12:15], s18 offen offset:0 sc1
    buffer_load_dwordx4 v[20:23], v1, s[12:15], s18 offen offset:1024 sc1
    buffer_load_dwordx4 v[24:27], v1, s[12:15], s18 offen offset:2048 sc1
    buffer_load_dwordx4 v[28:31], v1, s[12:15], s18 offen offset:3072 sc1
    s_sub_u32 s63, s63, 1
    s_cbranch_scc1 L_h2d
    s_waitcnt vmcnt(0)
    v_xor_b32 v12, v127, v19
    v_bitop3_b32 v12, v12, v23, v127 bitop3:0xf6
    v_bitop3_b32 v12, v12, v27, v127 bitop3:0xf6
    v_bitop3_b32 v12, v12, v31, v127 bitop3:0xf6
    v_cmp_ne_u32 vcc, 0, v12
    s_nop 0
    s_cbranch_vccnz L_h2p
L_h2d:
    s_waitcnt vmcnt(0)
    v_mov_b32 v12, 8
    ds_write_b32 v7, v12
    v_mov_b32_dpp v48, v18 quad_perm:[0,0,0,0] row_mask:0xf bank_mask:0xf
    v_mov_b32_dpp v49, v18 quad_perm:[1,1,1,1] row_mask:0xf bank_mask:0xf
    v_mov_b32_dpp v50, v22 quad_perm:[0,0,0,0] row_mask:0xf bank_mask:0xf
    v_mov_b32_dpp v51, v22 quad_perm:[1,1,1,1] row_mask:0xf bank_mask:0xf
    v_mov_b32_dpp v52, v26 quad_perm:[0,0,0,0] row_mask:0xf bank_mask:0xf
    v_mov_b32_dpp v53, v26 quad_perm:[1,1,1,1] row_mask:0xf bank_mask:0xf
    v_mov_b32_dpp v54, v30 quad_perm:[0,0,0,0] row_mask:0xf bank_mask:0xf
    v_mov_b32_dpp v55, v30 quad_perm:[1,1,1,1] row_mask:0xf bank_mask:0xf
    v_mov_b32 v18, v20
    v_mov_b32 v19, v21
    v_mov_b32 v26, v28
    v_mov_b32 v27, v29
    v_mfma_f32_16x16x32_bf16 v[80:83], v[48:51], v[32:35], 0
    v_mfma_f32_16x16x32_bf16 v[84:87], v[52:55], v[36:39], 0
    v_mfma_f32_16x16x32_bf16 v[88:91], v[48:51], v[40:43], 0
    v_mfma_f32_16x16x32_bf16 v[92:95], v[52:55], v[44:47], 0
    v_mfma_f32_16x16x32_bf16 v[64:67], v[16:19], v[32:35], 0
    v_mfma_f32_16x16x32_bf16 v[68:71], v[24:27], v[36:39], 0
    v_mfma_f32_16x16x32_bf16 v[72:75], v[16:19], v[40:43], 0
    v_mfma_f32_16x16x32_bf16 v[76:79], v[24:27], v[44:47], 0
    s_nop 0
    v_add_f32 v80, 0x358637bd, v80
    v_add_f32 v84, 0x358637bd, v84
    v_add_f32 v88, 0x358637bd, v88
    v_add_f32 v92, 0x358637bd, v92
    v_rcp_f32 v80, v80
    v_rcp_f32 v84, v84
    v_rcp_f32 v88, v88
    v_rcp_f32 v92, v92
    v_pk_mul_f32 v[64:65], v[64:65], v[80:81] op_sel:[0,0] op_sel_hi:[1,0]
    v_pk_mul_f32 v[66:67], v[66:67], v[80:81] op_sel:[0,0] op_sel_hi:[1,0]
    v_pk_mul_f32 v[68:69], v[68:69], v[84:85] op_sel:[0,0] op_sel_hi:[1,0]
    v_pk_mul_f32 v[70:71], v[70:71], v[84:85] op_sel:[0,0] op_sel_hi:[1,0]
    v_pk_mul_f32 v[72:73], v[72:73], v[88:89] op_sel:[0,0] op_sel_hi:[1,0]
    v_pk_mul_f32 v[74:75], v[74:75], v[88:89] op_sel:[0,0] op_sel_hi:[1,0]
    v_pk_mul_f32 v[76:77], v[76:77], v[92:93] op_sel:[0,0] op_sel_hi:[1,0]
    v_pk_mul_f32 v[78:79], v[78:79], v[92:93] op_sel:[0,0] op_sel_hi:[1,0]
    v_cvt_pk_bf16_f32 v56, v64, v65
    v_cvt_pk_bf16_f32 v57, v66, v67
    v_cvt_pk_bf16_f32 v58, v68, v69
    v_cvt_pk_bf16_f32 v59, v70, v71
    v_cvt_pk_bf16_f32 v60, v72, v73
    v_cvt_pk_bf16_f32 v61, v74, v75
    v_cvt_pk_bf16_f32 v62, v76, v77
    v_cvt_pk_bf16_f32 v63, v78, v79
    s_cmp_eq_u32 s58, 0
    s_cbranch_scc1 L_slow_19
    buffer_store_dwordx4 v[56:59], v1, s[12:15], s66 offen
    buffer_store_dwordx4 v[60:63], v1, s[12:15], s67 offen
L_sd_20:
    v_and_b32 v2, 15, v0
    v_lshrrev_b32 v3, 1, v2
    v_lshrrev_b32 v115, 5, v0
    v_xor_b32 v3, v3, v115
    v_lshlrev_b32 v3, 4, v3
    v_lshl_add_u32 v2, v2, 7, v3
    v_bfe_u32 v3, v0, 4, 1
    v_lshl_add_u32 v2, v3, 3, v2
    s_lshl_b32 s59, s53, 11
    s_add_u32 s59, s59, 152576
    v_add_u32 v116, s59, v2
    v_xor_b32 v117, 32, v116
    v_xor_b32 v118, 64, v116
    v_xor_b32 v119, 96, v116
    v_and_b32 v115, 48, v0
    v_add_u32 v115, 162816, v115
    ds_read_b64 v[24:25], v116
    ds_read_b64 v[26:27], v117
    ds_read_b64 v[28:29], v118
    ds_read_b64 v[30:31], v119
    v_mov_b32 v114, 0xffff0000
    s_waitcnt lgkmcnt(0)
    v_lshlrev_b32 v8, 16, v24
    v_and_b32 v9, v114, v24
    v_lshlrev_b32 v10, 16, v25
    v_and_b32 v11, v114, v25
    v_lshlrev_b32 v12, 16, v26
    v_and_b32 v13, v114, v26
    v_lshlrev_b32 v14, 16, v27
    v_and_b32 v15, v114, v27
    v_lshlrev_b32 v16, 16, v28
    v_and_b32 v17, v114, v28
    v_lshlrev_b32 v18, 16, v29
    v_and_b32 v19, v114, v29
    v_lshlrev_b32 v20, 16, v30
    v_and_b32 v21, v114, v30
    v_lshlrev_b32 v22, 16, v31
    v_and_b32 v23, v114, v31
    s_mov_b64 exec, 1
    s_cmp_eq_u32 s58, 0
    s_cbranch_scc1 L_slow_21
    s_waitcnt vmcnt(0)
    buffer_store_dword v127, v6, s[12:15], s68 offen
L_sd_22:
    s_mov_b64 exec, -1
    s_mov_b32 s63, 2097152
L_lw_23:
    ds_read_b32 v24, v4 offset:16
    s_sub_u32 s63, s63, 1
    s_cbranch_scc1 L_lwd_24
    s_waitcnt lgkmcnt(0)
    v_cmp_gt_u32 vcc, 16, v24
    s_nop 0
    s_cbranch_vccnz L_lw_23
L_lwd_24:
    ds_read_b64_tr_b16 v[48:49], v120 offset:0
    ds_read_b64_tr_b16 v[50:51], v120 offset:2048
    ds_read_b64_tr_b16 v[52:53], v121 offset:0
    ds_read_b64_tr_b16 v[54:55], v121 offset:2048
    ds_read_b64_tr_b16 v[56:57], v122 offset:0
    ds_read_b64_tr_b16 v[58:59], v122 offset:2048
    ds_read_b64_tr_b16 v[60:61], v123 offset:0
    ds_read_b64_tr_b16 v[62:63], v123 offset:2048
    ds_read_b64_tr_b16 v[64:65], v120 offset:4096
    ds_read_b64_tr_b16 v[66:67], v120 offset:6144
    ds_read_b64_tr_b16 v[68:69], v121 offset:4096
    ds_read_b64_tr_b16 v[70:71], v121 offset:6144
    ds_read_b64_tr_b16 v[72:73], v122 offset:4096
    ds_read_b64_tr_b16 v[74:75], v122 offset:6144
    ds_read_b64_tr_b16 v[76:77], v123 offset:4096
    ds_read_b64_tr_b16 v[78:79], v123 offset:6144
    s_mov_b32 s63, 262144
L_poll_25:
    buffer_load_dword v24, v5, s[12:15], s69 offen sc1
    s_sub_u32 s63, s63, 1
    s_cbranch_scc1 L_pd_26
    s_waitcnt vmcnt(0)
    v_cmp_ne_u32 vcc, s56, v24
    s_nop 0
    s_cbranch_vccnz L_poll_25
L_pd_26:
    buffer_load_dwordx4 a[0:3], v1, s[12:15], s70 offen offset:0 sc1
    buffer_load_dwordx4 a[4:7], v1, s[12:15], s70 offen offset:1024 sc1
    buffer_load_dwordx4 a[8:11], v1, s[12:15], s70 offen offset:2048 sc1
    buffer_load_dwordx4 a[12:15], v1, s[12:15], s70 offen offset:3072 sc1
    s_add_u32 s70, s70, 4096
    buffer_load_dwordx4 a[16:19], v1, s[12:15], s70 offen offset:0 sc1
    buffer_load_dwordx4 a[20:23], v1, s[12:15], s70 offen offset:1024 sc1
    buffer_load_dwordx4 a[24:27], v1, s[12:15], s70 offen offset:2048 sc1
    buffer_load_dwordx4 a[28:31], v1, s[12:15], s70 offen offset:3072 sc1
    s_add_u32 s70, s70, 4096
    s_waitcnt vmcnt(7) lgkmcnt(8)
    v_mfma_f32_16x16x32_bf16 v[32:35], v[48:51], a[0:3], 0
    buffer_load_dwordx4 a[32:35], v1, s[12:15], s70 offen offset:0 sc1
    ds_read_b64_tr_b16 v[80:81], v120 offset:8192
    ds_read_b64_tr_b16 v[82:83], v120 offset:10240
    v_mfma_f32_16x16x32_bf16 v[36:39], v[52:55], a[0:3], 0
    ds_read_b64_tr_b16 v[84:85], v121 offset:8192
    ds_read_b64_tr_b16 v[86:87], v121 offset:10240
    v_mfma_f32_16x16x32_bf16 v[40:43], v[56:59], a[0:3], 0
    ds_read_b64_tr_b16 v[88:89], v122 offset:8192
    ds_read_b64_tr_b16 v[90:91], v122 offset:10240
    v_mfma_f32_16x16x32_bf16 v[44:47], v[60:63], a[0:3], 0
    ds_read_b64_tr_b16 v[92:93], v123 offset:8192
    ds_read_b64_tr_b16 v[94:95], v123 offset:10240
    s_waitcnt vmcnt(7) lgkmcnt(8)
    v_mfma_f32_16x16x32_bf16 v[32:35], v[64:67], a[4:7], v[32:35]
    buffer_load_dwordx4 a[36:39], v1, s[12:15], s70 offen offset:1024 sc1
    ds_read_b64_tr_b16 v[48:49], v120 offset:12288
    ds_read_b64_tr_b16 v[50:51], v120 offset:14336
    v_mfma_f32_16x16x32_bf16 v[36:39], v[68:71], a[4:7], v[36:39]
    ds_read_b64_tr_b16 v[52:53], v121 offset:12288
    ds_read_b64_tr_b16 v[54:55], v121 offset:14336
    v_mfma_f32_16x16x32_bf16 v[40:43], v[72:75], a[4:7], v[40:43]
    ds_read_b64_tr_b16 v[56:57], v122 offset:12288
    ds_read_b64_tr_b16 v[58:59], v122 offset:14336
    v_mfma_f32_16x16x32_bf16 v[44:47], v[76:79], a[4:7], v[44:47]
    ds_read_b64_tr_b16 v[60:61], v123 offset:12288
    ds_read_b64_tr_b16 v[62:63], v123 offset:14336
    s_waitcnt vmcnt(7) lgkmcnt(8)
    v_mfma_f32_16x16x32_bf16 v[32:35], v[80:83], a[8:11], v[32:35]
    buffer_load_dwordx4 a[40:43], v1, s[12:15], s70 offen offset:2048 sc1
    ds_read_b64_tr_b16 v[64:65], v120 offset:16384
    ds_read_b64_tr_b16 v[66:67], v120 offset:18432
    v_mfma_f32_16x16x32_bf16 v[36:39], v[84:87], a[8:11], v[36:39]
    ds_read_b64_tr_b16 v[68:69], v121 offset:16384
    ds_read_b64_tr_b16 v[70:71], v121 offset:18432
    v_mfma_f32_16x16x32_bf16 v[40:43], v[88:91], a[8:11], v[40:43]
    ds_read_b64_tr_b16 v[72:73], v122 offset:16384
    ds_read_b64_tr_b16 v[74:75], v122 offset:18432
    v_mfma_f32_16x16x32_bf16 v[44:47], v[92:95], a[8:11], v[44:47]
    ds_read_b64_tr_b16 v[76:77], v123 offset:16384
    ds_read_b64_tr_b16 v[78:79], v123 offset:18432
    s_waitcnt vmcnt(7) lgkmcnt(8)
    v_mfma_f32_16x16x32_bf16 v[32:35], v[48:51], a[12:15], v[32:35]
    buffer_load_dwordx4 a[44:47], v1, s[12:15], s70 offen offset:3072 sc1
    ds_read_b64_tr_b16 v[80:81], v120 offset:20480
    ds_read_b64_tr_b16 v[82:83], v120 offset:22528
    v_mfma_f32_16x16x32_bf16 v[36:39], v[52:55], a[12:15], v[36:39]
    ds_read_b64_tr_b16 v[84:85], v121 offset:20480
    ds_read_b64_tr_b16 v[86:87], v121 offset:22528
    ds_read_b64_tr_b16 v[88:89], v122 offset:20480
    v_mfma_f32_16x16x32_bf16 v[40:43], v[56:59], a[12:15], v[40:43]
    ds_read_b64_tr_b16 v[90:91], v122 offset:22528
    ds_read_b64_tr_b16 v[92:93], v123 offset:20480
    v_mfma_f32_16x16x32_bf16 v[44:47], v[60:63], a[12:15], v[44:47]
    ds_read_b64_tr_b16 v[94:95], v123 offset:22528
    s_add_u32 s70, s70, 4096
    s_waitcnt vmcnt(7) lgkmcnt(8)
    v_mfma_f32_16x16x32_bf16 v[32:35], v[64:67], a[16:19], v[32:35]
    buffer_load_dwordx4 a[48:51], v1, s[12:15], s70 offen offset:0 sc1
    ds_read_b64_tr_b16 v[48:49], v120 offset:24576
    ds_read_b64_tr_b16 v[50:51], v120 offset:26624
    v_mfma_f32_16x16x32_bf16 v[36:39], v[68:71], a[16:19], v[36:39]
    ds_read_b64_tr_b16 v[52:53], v121 offset:24576
    ds_read_b64_tr_b16 v[54:55], v121 offset:26624
    v_mfma_f32_16x16x32_bf16 v[40:43], v[72:75], a[16:19], v[40:43]
    ds_read_b64_tr_b16 v[56:57], v122 offset:24576
    ds_read_b64_tr_b16 v[58:59], v122 offset:26624
    v_mfma_f32_16x16x32_bf16 v[44:47], v[76:79], a[16:19], v[44:47]
    ds_read_b64_tr_b16 v[60:61], v123 offset:24576
    ds_read_b64_tr_b16 v[62:63], v123 offset:26624
    s_waitcnt vmcnt(7) lgkmcnt(8)
    v_mfma_f32_16x16x32_bf16 v[32:35], v[80:83], a[20:23], v[32:35]
    buffer_load_dwordx4 a[52:55], v1, s[12:15], s70 offen offset:1024 sc1
    ds_read_b64_tr_b16 v[64:65], v120 offset:28672
    ds_read_b64_tr_b16 v[66:67], v120 offset:30720
    v_mfma_f32_16x16x32_bf16 v[36:39], v[84:87], a[20:23], v[36:39]
    ds_read_b64_tr_b16 v[68:69], v121 offset:28672
    ds_read_b64_tr_b16 v[70:71], v121 offset:30720
    v_mfma_f32_16x16x32_bf16 v[40:43], v[88:91], a[20:23], v[40:43]
    ds_read_b64_tr_b16 v[72:73], v122 offset:28672
    ds_read_b64_tr_b16 v[74:75], v122 offset:30720
    v_mfma_f32_16x16x32_bf16 v[44:47], v[92:95], a[20:23], v[44:47]
    ds_read_b64_tr_b16 v[76:77], v123 offset:28672
    ds_read_b64_tr_b16 v[78:79], v123 offset:30720
    s_waitcnt vmcnt(7) lgkmcnt(8)
    v_mfma_f32_16x16x32_bf16 v[32:35], v[48:51], a[24:27], v[32:35]
    buffer_load_dwordx4 a[56:59], v1, s[12:15], s70 offen offset:2048 sc1
    ds_read_b64_tr_b16 v[80:81], v120 offset:32768
    ds_read_b64_tr_b16 v[82:83], v120 offset:34816
    v_mfma_f32_16x16x32_bf16 v[36:39], v[52:55], a[24:27], v[36:39]
    ds_read_b64_tr_b16 v[84:85], v121 offset:32768
    ds_read_b64_tr_b16 v[86:87], v121 offset:34816
    v_mfma_f32_16x16x32_bf16 v[40:43], v[56:59], a[24:27], v[40:43]
    ds_read_b64_tr_b16 v[88:89], v122 offset:32768
    ds_read_b64_tr_b16 v[90:91], v122 offset:34816
    v_mfma_f32_16x16x32_bf16 v[44:47], v[60:63], a[24:27], v[44:47]
    ds_read_b64_tr_b16 v[92:93], v123 offset:32768
    ds_read_b64_tr_b16 v[94:95], v123 offset:34816
    s_waitcnt vmcnt(7) lgkmcnt(8)
    v_mfma_f32_16x16x32_bf16 v[32:35], v[64:67], a[28:31], v[32:35]
    buffer_load_dwordx4 a[60:63], v1, s[12:15], s70 offen offset:3072 sc1
    ds_read_b64_tr_b16 v[48:49], v120 offset:36864
    ds_read_b64_tr_b16 v[50:51], v120 offset:38912
    v_mfma_f32_16x16x32_bf16 v[36:39], v[68:71], a[28:31], v[36:39]
    ds_read_b64_tr_b16 v[52:53], v121 offset:36864
    ds_read_b64_tr_b16 v[54:55], v121 offset:38912
    v_mfma_f32_16x16x32_bf16 v[40:43], v[72:75], a[28:31], v[40:43]
    ds_read_b64_tr_b16 v[56:57], v122 offset:36864
    ds_read_b64_tr_b16 v[58:59], v122 offset:38912
    v_mfma_f32_16x16x32_bf16 v[44:47], v[76:79], a[28:31], v[44:47]
    ds_read_b64_tr_b16 v[60:61], v123 offset:36864
    ds_read_b64_tr_b16 v[62:63], v123 offset:38912
    s_waitcnt vmcnt(7) lgkmcnt(8)
    v_mfma_f32_16x16x32_bf16 v[32:35], v[80:83], a[32:35], v[32:35]
    v_mov_b32 v25, 9
    ds_write_b32 v7, v25
    ds_read_b64_tr_b16 v[64:65], v120 offset:40960
    v_mfma_f32_16x16x32_bf16 v[36:39], v[84:87], a[32:35], v[36:39]
    ds_read_b64_tr_b16 v[66:67], v120 offset:43008
    ds_read_b64_tr_b16 v[68:69], v121 offset:40960
    ds_read_b64_tr_b16 v[70:71], v121 offset:43008
    v_mfma_f32_16x16x32_bf16 v[40:43], v[88:91], a[32:35], v[40:43]
    ds_read_b64_tr_b16 v[72:73], v122 offset:40960
    ds_read_b64_tr_b16 v[74:75], v122 offset:43008
    v_mfma_f32_16x16x32_bf16 v[44:47], v[92:95], a[32:35], v[44:47]
    ds_read_b64_tr_b16 v[76:77], v123 offset:40960
    ds_read_b64_tr_b16 v[78:79], v123 offset:43008
    s_waitcnt vmcnt(6) lgkmcnt(9)
    v_mfma_f32_16x16x32_bf16 v[32:35], v[48:51], a[36:39], v[32:35]
    ds_read_b64_tr_b16 v[80:81], v120 offset:45056
    ds_read_b64_tr_b16 v[82:83], v120 offset:47104
    v_mfma_f32_16x16x32_bf16 v[36:39], v[52:55], a[36:39], v[36:39]
    ds_read_b64_tr_b16 v[84:85], v121 offset:45056
    ds_read_b64_tr_b16 v[86:87], v121 offset:47104
    v_mfma_f32_16x16x32_bf16 v[40:43], v[56:59], a[36:39], v[40:43]
    ds_read_b64_tr_b16 v[88:89], v122 offset:45056
    ds_read_b64_tr_b16 v[90:91], v122 offset:47104
    v_mfma_f32_16x16x32_bf16 v[44:47], v[60:63], a[36:39], v[44:47]
    ds_read_b64_tr_b16 v[92:93], v123 offset:45056
    ds_read_b64_tr_b16 v[94:95], v123 offset:47104
    s_waitcnt vmcnt(5) lgkmcnt(8)
    v_mfma_f32_16x16x32_bf16 v[32:35], v[64:67], a[40:43], v[32:35]
    ds_read_b64_tr_b16 v[48:49], v120 offset:49152
    ds_read_b64_tr_b16 v[50:51], v120 offset:51200
    v_mfma_f32_16x16x32_bf16 v[36:39], v[68:71], a[40:43], v[36:39]
    ds_read_b64_tr_b16 v[52:53], v121 offset:49152
    ds_read_b64_tr_b16 v[54:55], v121 offset:51200
    v_mfma_f32_16x16x32_bf16 v[40:43], v[72:75], a[40:43], v[40:43]
    ds_read_b64_tr_b16 v[56:57], v122 offset:49152
    ds_read_b64_tr_b16 v[58:59], v122 offset:51200
    v_mfma_f32_16x16x32_bf16 v[44:47], v[76:79], a[40:43], v[44:47]
    ds_read_b64_tr_b16 v[60:61], v123 offset:49152
    ds_read_b64_tr_b16 v[62:63], v123 offset:51200
    s_waitcnt vmcnt(4) lgkmcnt(8)
    v_mfma_f32_16x16x32_bf16 v[32:35], v[80:83], a[44:47], v[32:35]
    ds_read_b32 v24, v4 offset:48
    ds_read_b64_tr_b16 v[64:65], v120 offset:53248
    ds_read_b64_tr_b16 v[66:67], v120 offset:55296
    v_mfma_f32_16x16x32_bf16 v[36:39], v[84:87], a[44:47], v[36:39]
    ds_read_b64_tr_b16 v[68:69], v121 offset:53248
    ds_read_b64_tr_b16 v[70:71], v121 offset:55296
    v_mfma_f32_16x16x32_bf16 v[40:43], v[88:91], a[44:47], v[40:43]
    ds_read_b64_tr_b16 v[72:73], v122 offset:53248
    ds_read_b64_tr_b16 v[74:75], v122 offset:55296
    v_mfma_f32_16x16x32_bf16 v[44:47], v[92:95], a[44:47], v[44:47]
    ds_read_b64_tr_b16 v[76:77], v123 offset:53248
    ds_read_b64_tr_b16 v[78:79], v123 offset:55296
    s_waitcnt vmcnt(3) lgkmcnt(9)
    v_mfma_f32_16x16x32_bf16 v[32:35], v[48:51], a[48:51], v[32:35]
    ds_read_b64_tr_b16 v[80:81], v120 offset:57344
    ds_read_b64_tr_b16 v[82:83], v120 offset:59392
    v_mfma_f32_16x16x32_bf16 v[36:39], v[52:55], a[48:51], v[36:39]
    ds_read_b64_tr_b16 v[84:85], v121 offset:57344
    ds_read_b64_tr_b16 v[86:87], v121 offset:59392
    v_mfma_f32_16x16x32_bf16 v[40:43], v[56:59], a[48:51], v[40:43]
    ds_read_b64_tr_b16 v[88:89], v122 offset:57344
    ds_read_b64_tr_b16 v[90:91], v122 offset:59392
    v_mfma_f32_16x16x32_bf16 v[44:47], v[60:63], a[48:51], v[44:47]
    ds_read_b64_tr_b16 v[92:93], v123 offset:57344
    ds_read_b64_tr_b16 v[94:95], v123 offset:59392
    s_waitcnt vmcnt(2) lgkmcnt(8)
    v_mfma_f32_16x16x32_bf16 v[32:35], v[64:67], a[52:55], v[32:35]
    ds_read_b64_tr_b16 v[48:49], v120 offset:61440
    ds_read_b64_tr_b16 v[50:51], v120 offset:63488
    v_mfma_f32_16x16x32_bf16 v[36:39], v[68:71], a[52:55], v[36:39]
    ds_read_b64_tr_b16 v[52:53], v121 offset:61440
    ds_read_b64_tr_b16 v[54:55], v121 offset:63488
    v_mfma_f32_16x16x32_bf16 v[40:43], v[72:75], a[52:55], v[40:43]
    ds_read_b64_tr_b16 v[56:57], v122 offset:61440
    ds_read_b64_tr_b16 v[58:59], v122 offset:63488
    v_mfma_f32_16x16x32_bf16 v[44:47], v[76:79], a[52:55], v[44:47]
    ds_read_b64_tr_b16 v[60:61], v123 offset:61440
    ds_read_b64_tr_b16 v[62:63], v123 offset:63488
    s_waitcnt vmcnt(1) lgkmcnt(8)
    v_mfma_f32_16x16x32_bf16 v[32:35], v[80:83], a[56:59], v[32:35]
    v_cmp_gt_u32 vcc, 1, v24
    s_nop 0
    s_cbranch_vccnz L_cks_27
L_ck_28:
    v_mfma_f32_16x16x32_bf16 v[36:39], v[84:87], a[56:59], v[36:39]
    ds_read_b128 v[96:99], v115 offset:0
    ds_read_b128 v[100:103], v115 offset:64
    ds_read_b128 v[104:107], v115 offset:128
    v_mfma_f32_16x16x32_bf16 v[40:43], v[88:91], a[56:59], v[40:43]
    ds_read_b128 v[108:111], v115 offset:192
    v_mov_b32 v24, 0
    v_mfma_f32_16x16x32_bf16 v[44:47], v[92:95], a[56:59], v[44:47]
    v_mov_b32 v25, 0
    v_mov_b32 v28, 0x3f803f80
    s_waitcnt vmcnt(0) lgkmcnt(4)
    v_mfma_f32_16x16x32_bf16 v[32:35], v[48:51], a[60:63], v[32:35]
    v_mov_b32 v26, 10
    ds_write_b32 v7, v26
    ds_read_b128 v[64:67], v115 offset:256
    v_mfma_f32_16x16x32_bf16 v[36:39], v[52:55], a[60:63], v[36:39]
    ds_read_b128 v[68:71], v115 offset:320
    ds_read_b128 v[72:75], v115 offset:384
    ds_read_b128 v[76:79], v115 offset:448
    v_mfma_f32_16x16x32_bf16 v[40:43], v[56:59], a[60:63], v[40:43]
    ds_read_b128 v[80:83], v115 offset:512
    ds_read_b128 v[84:87], v115 offset:576
    v_mfma_f32_16x16x32_bf16 v[44:47], v[60:63], a[60:63], v[44:47]
    ds_read_b128 v[88:91], v115 offset:640
    ds_read_b128 v[92:95], v115 offset:704
    v_mov_b32 v26, v127
    v_mov_b32 v27, v127
    s_waitcnt lgkmcnt(9)
    v_pk_fma_f32 v[8:9], v[32:33], v[96:97], v[8:9]
    v_pk_fma_f32 v[10:11], v[34:35], v[98:99], v[10:11]
    v_pk_fma_f32 v[12:13], v[36:37], v[100:101], v[12:13]
    v_pk_fma_f32 v[14:15], v[38:39], v[102:103], v[14:15]
    v_pk_fma_f32 v[16:17], v[40:41], v[104:105], v[16:17]
    v_pk_fma_f32 v[18:19], v[42:43], v[106:107], v[18:19]
    v_pk_fma_f32 v[20:21], v[44:45], v[108:109], v[20:21]
    v_pk_fma_f32 v[22:23], v[46:47], v[110:111], v[22:23]
    v_cvt_pk_bf16_f32 v48, v8, v9
    v_cvt_pk_bf16_f32 v49, v10, v11
    v_cvt_pk_bf16_f32 v50, v12, v13
    v_cvt_pk_bf16_f32 v51, v14, v15
    v_cvt_pk_bf16_f32 v52, v16, v17
    v_cvt_pk_bf16_f32 v53, v18, v19
    v_cvt_pk_bf16_f32 v54, v20, v21
    v_cvt_pk_bf16_f32 v55, v22, v23
    v_dot2c_f32_bf16 v24, v28, v48
    v_dot2c_f32_bf16 v25, v48, v48
    v_dot2c_f32_bf16 v24, v28, v49
    v_dot2c_f32_bf16 v25, v49, v49
    v_dot2c_f32_bf16 v24, v28, v50
    v_dot2c_f32_bf16 v25, v50, v50
    v_dot2c_f32_bf16 v24, v28, v51
    v_dot2c_f32_bf16 v25, v51, v51
    v_dot2c_f32_bf16 v24, v28, v52
    v_dot2c_f32_bf16 v25, v52, v52
    v_dot2c_f32_bf16 v24, v28, v53
    v_dot2c_f32_bf16 v25, v53, v53
    v_dot2c_f32_bf16 v24, v28, v54
    v_dot2c_f32_bf16 v25, v54, v54
    v_dot2c_f32_bf16 v24, v28, v55
    v_dot2c_f32_bf16 v25, v55, v55
    s_nop 2
    v_permlane32_swap_b32 v24, v25
    v_add_f32 v24, v24, v25
    v_mov_b32 v25, v24
    s_nop 1
    v_permlane16_swap_b32 v24, v25
    v_add_f32 v24, v24, v25
    v_mov_b32 v25, v24
    s_nop 1
    v_permlane32_swap_b32 v24, v25
    s_mov_b64 exec, 0xffff
    s_cmp_eq_u32 s58, 0
    s_cbranch_scc1 L_slow_31
    buffer_store_dwordx4 v[24:27], v1, s[12:15], s73 offen
L_sd_32:
    s_mov_b64 exec, -1
    ds_write_b64 v116, v[48:49]
    ds_write_b64 v117, v[50:51]
    ds_write_b64 v118, v[52:53]
    ds_write_b64 v119, v[54:55]
    v_lshlrev_b32 v8, 16, v48
    v_and_b32 v9, v126, v48
    v_lshlrev_b32 v10, 16, v49
    v_and_b32 v11, v126, v49
    v_lshlrev_b32 v12, 16, v50
    v_and_b32 v13, v126, v50
    v_lshlrev_b32 v14, 16, v51
    v_and_b32 v15, v126, v51
    v_lshlrev_b32 v16, 16, v52
    v_and_b32 v17, v126, v52
    v_lshlrev_b32 v18, 16, v53
    v_and_b32 v19, v126, v53
    v_lshlrev_b32 v20, 16, v54
    v_and_b32 v21, v126, v54
    v_lshlrev_b32 v22, 16, v55
    v_and_b32 v23, v126, v55
    s_waitcnt lgkmcnt(0)
    v_pk_mul_f32 v[8:9], v[8:9], v[80:81]
    v_pk_mul_f32 v[10:11], v[10:11], v[82:83]
    v_pk_mul_f32 v[12:13], v[12:13], v[84:85]
    v_pk_mul_f32 v[14:15], v[14:15], v[86:87]
    v_pk_mul_f32 v[16:17], v[16:17], v[88:89]
    v_pk_mul_f32 v[18:19], v[18:19], v[90:91]
    v_pk_mul_f32 v[20:21], v[20:21], v[92:93]
    v_pk_mul_f32 v[22:23], v[22:23], v[94:95]
    s_mov_b32 s63, 262144
L_st:
    buffer_load_dwordx4 v[32:35], v1, s[12:15], s72 offen offset:0 sc1
    buffer_load_dwordx4 v[36:39], v1, s[12:15], s72 offen offset:1024 sc1
    s_sub_u32 s63, s63, 1
    s_cbranch_scc1 L_std
    s_waitcnt vmcnt(0)
    v_xor_b32 v28, v127, v34
    v_bitop3_b32 v28, v28, v38, v127 bitop3:0xf6
    v_pk_add_f32 v[30:31], v[32:33], v[36:37]
    v_cmp_ne_u32 vcc, 0, v28
    s_nop 0
    s_cbranch_vccnz L_st
L_std:
    v_permlane32_swap_b32 v30, v31
    v_add_f32 v30, v30, v31
    v_mov_b32 v31, v30
    v_mov_b32 v28, 12
    s_nop 0
    v_permlane16_swap_b32 v30, v31
    v_add_f32 v30, v30, v31
    v_mul_f32 v30, 0x3b000000, v30
    v_mov_b32 v31, v30
    ds_write_b32 v7, v28
    s_nop 0
    v_permlane32_swap_b32 v30, v31
    v_fma_f32 v31, -v30, v30, v31
    v_max_f32 v31, 0, v31
    v_add_f32 v31, 0x3727c5ac, v31
    v_rsq_f32 v31, v31
    s_nop 0
    v_pk_fma_f32 v[8:9], v[80:81], v[30:31], v[8:9] op_sel:[0,0,0] op_sel_hi:[1,0,1] neg_lo:[0,1,0] neg_hi:[0,1,0]
    v_pk_fma_f32 v[10:11], v[82:83], v[30:31], v[10:11] op_sel:[0,0,0] op_sel_hi:[1,0,1] neg_lo:[0,1,0] neg_hi:[0,1,0]
    v_pk_fma_f32 v[12:13], v[84:85], v[30:31], v[12:13] op_sel:[0,0,0] op_sel_hi:[1,0,1] neg_lo:[0,1,0] neg_hi:[0,1,0]
    v_pk_fma_f32 v[14:15], v[86:87], v[30:31], v[14:15] op_sel:[0,0,0] op_sel_hi:[1,0,1] neg_lo:[0,1,0] neg_hi:[0,1,0]
    v_pk_fma_f32 v[16:17], v[88:89], v[30:31], v[16:17] op_sel:[0,0,0] op_sel_hi:[1,0,1] neg_lo:[0,1,0] neg_hi:[0,1,0]
    v_pk_fma_f32 v[18:19], v[90:91], v[30:31], v[18:19] op_sel:[0,0,0] op_sel_hi:[1,0,1] neg_lo:[0,1,0] neg_hi:[0,1,0]
    v_pk_fma_f32 v[20:21], v[92:93], v[30:31], v[20:21] op_sel:[0,0,0] op_sel_hi:[1,0,1] neg_lo:[0,1,0] neg_hi:[0,1,0]
    v_pk_fma_f32 v[22:23], v[94:95], v[30:31], v[22:23] op_sel:[0,0,0] op_sel_hi:[1,0,1] neg_lo:[0,1,0] neg_hi:[0,1,0]
    v_pk_fma_f32 v[8:9], v[8:9], v[30:31], v[64:65] op_sel:[0,1,0] op_sel_hi:[1,1,1]
    v_pk_fma_f32 v[10:11], v[10:11], v[30:31], v[66:67] op_sel:[0,1,0] op_sel_hi:[1,1,1]
    v_pk_fma_f32 v[12:13], v[12:13], v[30:31], v[68:69] op_sel:[0,1,0] op_sel_hi:[1,1,1]
    v_pk_fma_f32 v[14:15], v[14:15], v[30:31], v[70:71] op_sel:[0,1,0] op_sel_hi:[1,1,1]
    v_pk_fma_f32 v[16:17], v[16:17], v[30:31], v[72:73] op_sel:[0,1,0] op_sel_hi:[1,1,1]
    v_pk_fma_f32 v[18:19], v[18:19], v[30:31], v[74:75] op_sel:[0,1,0] op_sel_hi:[1,1,1]
    v_pk_fma_f32 v[20:21], v[20:21], v[30:31], v[76:77] op_sel:[0,1,0] op_sel_hi:[1,1,1]
    v_pk_fma_f32 v[22:23], v[22:23], v[30:31], v[78:79] op_sel:[0,1,0] op_sel_hi:[1,1,1]
    v_cvt_pk_bf16_f32 v32, v8, v9
    v_cvt_pk_bf16_f32 v33, v10, v11
    v_cvt_pk_bf16_f32 v34, v12, v13
    v_cvt_pk_bf16_f32 v35, v14, v15
    v_cvt_pk_bf16_f32 v36, v16, v17
    v_cvt_pk_bf16_f32 v37, v18, v19
    v_cvt_pk_bf16_f32 v38, v20, v21
    v_cvt_pk_bf16_f32 v39, v22, v23
    s_cmp_eq_u32 s58, 0
    s_cbranch_scc1 L_slow_33
    buffer_store_dwordx4 v[32:35], v1, s[12:15], s71 offen
    buffer_store_dwordx4 v[36:39], v1, s[12:15], s71 offen offset:1024
L_sd_34:
    s_mov_b64 exec, 1
    s_cmp_eq_u32 s58, 0
    s_cbranch_scc1 L_slow_35
    s_waitcnt vmcnt(0)
    buffer_store_dword v127, v6, s[12:15], s74 offen
L_sd_36:
    s_mov_b64 exec, -1
    s_lshl_b32 s60, s53, 17
    s_add_u32 s60, s60, s57
    v_add_u32 v3, s60, v1
    s_lshl_b32 s59, s54, 10
    s_or_b32 s62, s59, 16384
    s_mul_i32 s60, s55, 3072
    s_add_u32 s60, s60, 0x8000
    s_add_u32 s61, s60, 49152
    s_cmp_eq_u32 s55, 15
    s_cbranch_scc1 L_p3_idle
    v_lshrrev_b32 v2, 2, v0
    v_mul_u32_u24 v2, 192, v2
    v_and_b32 v1, 3, v0
    v_lshl_add_u32 v2, v1, 3, v2
    v_and_b32 v1, 16, v0
    v_lshl_add_u32 v2, v1, 1, v2
    v_add_u32 v2, 98304, v2
    v_xor_b32 v6, 32, v2
    ds_read_b64_tr_b16 v[8:9], v2 offset:0
    ds_read_b64_tr_b16 v[10:11], v2 offset:3072
    ds_read_b64_tr_b16 v[12:13], v2 offset:6144
    ds_read_b64_tr_b16 v[14:15], v2 offset:9216
    ds_read_b64_tr_b16 v[16:17], v6 offset:0
    ds_read_b64_tr_b16 v[18:19], v6 offset:3072
    ds_read_b64_tr_b16 v[20:21], v6 offset:6144
    ds_read_b64_tr_b16 v[22:23], v6 offset:9216
    ds_read_b64_tr_b16 v[24:25], v2 offset:64
    ds_read_b64_tr_b16 v[26:27], v2 offset:3136
    s_mov_b32 s63, 262144
L_poll_37:
    buffer_load_dword v32, v5, s[12:15], s75 offen sc1
    s_sub_u32 s63, s63, 1
    s_cbranch_scc1 L_pd_38
    s_waitcnt vmcnt(0)
    v_cmp_ne_u32 vcc, s56, v32
    s_nop 0
    s_cbranch_vccnz L_poll_37
L_pd_38:
    buffer_load_dwordx4 a[0:3], v3, s[12:15], s59 offen offset:0 sc1
    buffer_load_dwordx4 a[4:7], v3, s[12:15], s62 offen offset:0 sc1
    buffer_load_dwordx4 a[8:11], v3, s[12:15], s59 offen offset:1024 sc1
    buffer_load_dwordx4 a[12:15], v3, s[12:15], s62 offen offset:1024 sc1
    s_add_u32 s59, s59, 2048
    s_and_b32 s59, s59, 0x3fff
    s_or_b32 s62, s59, 16384
    buffer_load_dwordx4 a[16:19], v3, s[12:15], s59 offen offset:0 sc1
    buffer_load_dwordx4 a[20:23], v3, s[12:15], s62 offen offset:0 sc1
    buffer_load_dwordx4 a[24:27], v3, s[12:15], s59 offen offset:1024 sc1
    buffer_load_dwordx4 a[28:31], v3, s[12:15], s62 offen offset:1024 sc1
    s_add_u32 s59, s59, 2048
    s_and_b32 s59, s59, 0x3fff
    s_or_b32 s62, s59, 16384
    v_mov_b32 v1, 15
    ds_write_b32 v7, v1
    s_waitcnt vmcnt(6) lgkmcnt(9)
    v_mfma_f32_16x16x32_bf16 v[32:35], v[8:11], a[0:3], 0
    ds_read_b32 v5, v4 offset:16
    ds_read_b64_tr_b16 v[28:29], v2 offset:6208
    v_mfma_f32_16x16x32_bf16 v[56:59], v[8:11], a[4:7], 0
    ds_read_b64_tr_b16 v[30:31], v2 offset:9280
    s_waitcnt lgkmcnt(10)
    v_mfma_f32_16x16x32_bf16 v[80:83], v[12:15], a[0:3], 0
    buffer_load_dwordx4 a[32:35], v3, s[12:15], s59 offen offset:0 sc1
    ds_read_b64_tr_b16 v[8:9], v6 offset:64
    v_mfma_f32_16x16x32_bf16 v[104:107], v[12:15], a[4:7], 0
    ds_read_b64_tr_b16 v[10:11], v6 offset:3136
    s_waitcnt lgkmcnt(10)
    v_mfma_f32_16x16x32_bf16 v[36:39], v[16:19], a[0:3], 0
    buffer_load_dwordx4 a[36:39], v3, s[12:15], s62 offen offset:0 sc1
    ds_read_b64_tr_b16 v[12:13], v6 offset:6208
    v_mfma_f32_16x16x32_bf16 v[60:63], v[16:19], a[4:7], 0
    ds_read_b64_tr_b16 v[14:15], v6 offset:9280
    s_waitcnt lgkmcnt(10)
    v_mfma_f32_16x16x32_bf16 v[84:87], v[20:23], a[0:3], 0
    ds_read_b64_tr_b16 v[16:17], v2 offset:128
    v_mfma_f32_16x16x32_bf16 v[108:111], v[20:23], a[4:7], 0
    ds_read_b64_tr_b16 v[18:19], v2 offset:3200
    s_waitcnt lgkmcnt(10)
    v_mfma_f32_16x16x32_bf16 v[40:43], v[24:27], a[0:3], 0
    ds_read_b64_tr_b16 v[20:21], v2 offset:6272
    v_mfma_f32_16x16x32_bf16 v[64:67], v[24:27], a[4:7], 0
    ds_read_b64_tr_b16 v[22:23], v2 offset:9344
    s_waitcnt lgkmcnt(8)
    v_mfma_f32_16x16x32_bf16 v[88:91], v[28:31], a[0:3], 0
    ds_read_b64_tr_b16 v[24:25], v6 offset:128
    v_mfma_f32_16x16x32_bf16 v[112:115], v[28:31], a[4:7], 0
    ds_read_b64_tr_b16 v[26:27], v6 offset:3200
    s_waitcnt lgkmcnt(8)
    v_mfma_f32_16x16x32_bf16 v[44:47], v[8:11], a[0:3], 0
    ds_read_b64_tr_b16 v[28:29], v6 offset:6272
    v_mfma_f32_16x16x32_bf16 v[68:71], v[8:11], a[4:7], 0
    ds_read_b64_tr_b16 v[30:31], v6 offset:9344
    s_waitcnt lgkmcnt(8)
    v_mfma_f32_16x16x32_bf16 v[92:95], v[12:15], a[0:3], 0
    v_cmp_gt_u32 vcc, 17, v5
    s_nop 0
    s_cbranch_vccnz L_cks_39
L_ck_40:
    ds_read_b64_tr_b16 v[8:9], v2 offset:12288
    v_mfma_f32_16x16x32_bf16 v[116:119], v[12:15], a[4:7], 0
    ds_read_b64_tr_b16 v[10:11], v2 offset:15360
    s_waitcnt lgkmcnt(8)
    v_mfma_f32_16x16x32_bf16 v[48:51], v[16:19], a[0:3], 0
    ds_read_b64_tr_b16 v[12:13], v2 offset:18432
    v_mfma_f32_16x16x32_bf16 v[72:75], v[16:19], a[4:7], 0
    ds_read_b64_tr_b16 v[14:15], v2 offset:21504
    s_waitcnt lgkmcnt(8)
    v_mfma_f32_16x16x32_bf16 v[96:99], v[20:23], a[0:3], 0
    ds_read_b64_tr_b16 v[16:17], v6 offset:12288
    v_mfma_f32_16x16x32_bf16 v[120:123], v[20:23], a[4:7], 0
    ds_read_b64_tr_b16 v[18:19], v6 offset:15360
    s_waitcnt lgkmcnt(8)
    v_mfma_f32_16x16x32_bf16 v[52:55], v[24:27], a[0:3], 0
    ds_read_b64_tr_b16 v[20:21], v6 offset:18432
    v_mfma_f32_16x16x32_bf16 v[76:79], v[24:27], a[4:7], 0
    ds_read_b64_tr_b16 v[22:23], v6 offset:21504
    s_waitcnt lgkmcnt(8)
    v_mfma_f32_16x16x32_bf16 v[100:103], v[28:31], a[0:3], 0
    ds_read_b64_tr_b16 v[24:25], v2 offset:12352
    v_mfma_f32_16x16x32_bf16 v[124:127], v[28:31], a[4:7], 0
    ds_read_b64_tr_b16 v[26:27], v2 offset:15424
    s_waitcnt vmcnt(6) lgkmcnt(8)
    v_mfma_f32_16x16x32_bf16 v[32:35], v[8:11], a[8:11], v[32:35]
    ds_read_b32 v5, v4 offset:16
    ds_read_b64_tr_b16 v[28:29], v2 offset:18496
    v_mfma_f32_16x16x32_bf16 v[56:59], v[8:11], a[12:15], v[56:59]
    ds_read_b64_tr_b16 v[30:31], v2 offset:21568
    s_waitcnt lgkmcnt(9)
    v_mfma_f32_16x16x32_bf16 v[80:83], v[12:15], a[8:11], v[80:83]
    v_mov_b32 v1, 16
    ds_read_b64_tr_b16 v[8:9], v6 offset:12352
    v_mfma_f32_16x16x32_bf16 v[104:107], v[12:15], a[12:15], v[104:107]
    ds_read_b64_tr_b16 v[10:11], v6 offset:15424
    s_waitcnt lgkmcnt(9)
    v_mfma_f32_16x16x32_bf16 v[36:39], v[16:19], a[8:11], v[36:39]
    ds_write_b32 v7, v1
    ds_read_b64_tr_b16 v[12:13], v6 offset:18496
    v_mfma_f32_16x16x32_bf16 v[60:63], v[16:19], a[12:15], v[60:63]
    ds_read_b64_tr_b16 v[14:15], v6 offset:21568
    s_waitcnt lgkmcnt(10)
    v_mfma_f32_16x16x32_bf16 v[84:87], v[20:23], a[8:11], v[84:87]
    buffer_load_dwordx4 a[40:43], v3, s[12:15], s59 offen offset:1024 sc1
    ds_read_b64_tr_b16 v[16:17], v2 offset:12416
    v_mfma_f32_16x16x32_bf16 v[108:111], v[20:23], a[12:15], v[108:111]
    ds_read_b64_tr_b16 v[18:19], v2 offset:15488
    s_waitcnt lgkmcnt(10)
    v_mfma_f32_16x16x32_bf16 v[40:43], v[24:27], a[8:11], v[40:43]
    buffer_load_dwordx4 a[44:47], v3, s[12:15], s62 offen offset:1024 sc1
    ds_read_b64_tr_b16 v[20:21], v2 offset:18560
    v_mfma_f32_16x16x32_bf16 v[64:67], v[24:27], a[12:15], v[64:67]
    ds_read_b64_tr_b16 v[22:23], v2 offset:21632
    s_waitcnt lgkmcnt(9)
    v_mfma_f32_16x16x32_bf16 v[88:91], v[28:31], a[8:11], v[88:91]
    s_add_u32 s59, s59, 2048
    ds_read_b64_tr_b16 v[24:25], v6 offset:12416
    v_mfma_f32_16x16x32_bf16 v[112:115], v[28:31], a[12:15], v[112:115]
    ds_read_b64_tr_b16 v[26:27], v6 offset:15488
    s_waitcnt lgkmcnt(9)
    v_mfma_f32_16x16x32_bf16 v[44:47], v[8:11], a[8:11], v[44:47]
    s_and_b32 s59, s59, 0x3fff
    ds_read_b64_tr_b16 v[28:29], v6 offset:18560
    v_mfma_f32_16x16x32_bf16 v[68:71], v[8:11], a[12:15], v[68:71]
    ds_read_b64_tr_b16 v[30:31], v6 offset:21632
    s_waitcnt lgkmcnt(8)
    v_mfma_f32_16x16x32_bf16 v[92:95], v[12:15], a[8:11], v[92:95]
    v_cmp_gt_u32 vcc, 18, v5
    s_nop 0
    s_cbranch_vccnz L_cks_43
L_ck_44:
    ds_read_b64_tr_b16 v[8:9], v2 offset:24576
    v_mfma_f32_16x16x32_bf16 v[116:119], v[12:15], a[12:15], v[116:119]
    ds_read_b64_tr_b16 v[10:11], v2 offset:27648
    s_waitcnt lgkmcnt(8)
    v_mfma_f32_16x16x32_bf16 v[48:51], v[16:19], a[8:11], v[48:51]
    s_or_b32 s62, s59, 16384
    ds_read_b64_tr_b16 v[12:13], v2 offset:30720
    v_mfma_f32_16x16x32_bf16 v[72:75], v[16:19], a[12:15], v[72:75]
    ds_read_b64_tr_b16 v[14:15], v2 offset:33792
    s_waitcnt lgkmcnt(8)
    v_mfma_f32_16x16x32_bf16 v[96:99], v[20:23], a[8:11], v[96:99]
    ds_read_b64_tr_b16 v[16:17], v6 offset:24576
    v_mfma_f32_16x16x32_bf16 v[120:123], v[20:23], a[12:15], v[120:123]
    ds_read_b64_tr_b16 v[18:19], v6 offset:27648
    s_waitcnt lgkmcnt(8)
    v_mfma_f32_16x16x32_bf16 v[52:55], v[24:27], a[8:11], v[52:55]
    ds_read_b64_tr_b16 v[20:21], v6 offset:30720
    v_mfma_f32_16x16x32_bf16 v[76:79], v[24:27], a[12:15], v[76:79]
    ds_read_b64_tr_b16 v[22:23], v6 offset:33792
    s_waitcnt lgkmcnt(8)
    v_mfma_f32_16x16x32_bf16 v[100:103], v[28:31], a[8:11], v[100:103]
    ds_read_b64_tr_b16 v[24:25], v2 offset:24640
    v_mfma_f32_16x16x32_bf16 v[124:127], v[28:31], a[12:15], v[124:127]
    ds_read_b64_tr_b16 v[26:27], v2 offset:27712
    s_waitcnt vmcnt(6) lgkmcnt(8)
    v_mfma_f32_16x16x32_bf16 v[32:35], v[8:11], a[16:19], v[32:35]
    ds_read_b32 v5, v4 offset:16
    ds_read_b64_tr_b16 v[28:29], v2 offset:30784
    v_mfma_f32_16x16x32_bf16 v[56:59], v[8:11], a[20:23], v[56:59]
    ds_read_b64_tr_b16 v[30:31], v2 offset:33856
    s_waitcnt lgkmcnt(9)
    v_mfma_f32_16x16x32_bf16 v[80:83], v[12:15], a[16:19], v[80:83]
    v_mov_b32 v1, 17
    ds_read_b64_tr_b16 v[8:9], v6 offset:24640
    v_mfma_f32_16x16x32_bf16 v[104:107], v[12:15], a[20:23], v[104:107]
    ds_read_b64_tr_b16 v[10:11], v6 offset:27712
    s_waitcnt lgkmcnt(9)
    v_mfma_f32_16x16x32_bf16 v[36:39], v[16:19], a[16:19], v[36:39]
    ds_write_b32 v7, v1
    ds_read_b64_tr_b16 v[12:13], v6 offset:30784
    v_mfma_f32_16x16x32_bf16 v[60:63], v[16:19], a[20:23], v[60:63]
    ds_read_b64_tr_b16 v[14:15], v6 offset:33856
    s_waitcnt lgkmcnt(10)
    v_mfma_f32_16x16x32_bf16 v[84:87], v[20:23], a[16:19], v[84:87]
    buffer_load_dwordx4 a[48:51], v3, s[12:15], s59 offen offset:0 sc1
    ds_read_b64_tr_b16 v[16:17], v2 offset:24704
    v_mfma_f32_16x16x32_bf16 v[108:111], v[20:23], a[20:23], v[108:111]
    ds_read_b64_tr_b16 v[18:19], v2 offset:27776
    s_waitcnt lgkmcnt(10)
    v_mfma_f32_16x16x32_bf16 v[40:43], v[24:27], a[16:19], v[40:43]
    buffer_load_dwordx4 a[52:55], v3, s[12:15], s62 offen offset:0 sc1
    ds_read_b64_tr_b16 v[20:21], v2 offset:30848
    v_mfma_f32_16x16x32_bf16 v[64:67], v[24:27], a[20:23], v[64:67]
    ds_read_b64_tr_b16 v[22:23], v2 offset:33920
    s_waitcnt lgkmcnt(9)
    v_mfma_f32_16x16x32_bf16 v[88:91], v[28:31], a[16:19], v[88:91]
    ds_read_b64_tr_b16 v[24:25], v6 offset:24704
    v_mfma_f32_16x16x32_bf16 v[112:115], v[28:31], a[20:23], v[112:115]
    ds_read_b64_tr_b16 v[26:27], v6 offset:27776
    s_waitcnt lgkmcnt(9)
    v_mfma_f32_16x16x32_bf16 v[44:47], v[8:11], a[16:19], v[44:47]
    ds_read_b64_tr_b16 v[28:29], v6 offset:30848
    v_mfma_f32_16x16x32_bf16 v[68:71], v[8:11], a[20:23], v[68:71]
    ds_read_b64_tr_b16 v[30:31], v6 offset:33920
    s_waitcnt lgkmcnt(8)
    v_mfma_f32_16x16x32_bf16 v[92:95], v[12:15], a[16:19], v[92:95]
    v_cmp_gt_u32 vcc, 19, v5
    s_nop 0
    s_cbranch_vccnz L_cks_47
L_ck_48:
    ds_read_b64_tr_b16 v[8:9], v2 offset:36864
    v_mfma_f32_16x16x32_bf16 v[116:119], v[12:15], a[20:23], v[116:119]
    ds_read_b64_tr_b16 v[10:11], v2 offset:39936
    s_waitcnt lgkmcnt(8)
    v_mfma_f32_16x16x32_bf16 v[48:51], v[16:19], a[16:19], v[48:51]
    ds_read_b64_tr_b16 v[12:13], v2 offset:43008
    v_mfma_f32_16x16x32_bf16 v[72:75], v[16:19], a[20:23], v[72:75]
    ds_read_b64_tr_b16 v[14:15], v2 offset:46080
    s_waitcnt lgkmcnt(8)
    v_mfma_f32_16x16x32_bf16 v[96:99], v[20:23], a[16:19], v[96:99]
    ds_read_b64_tr_b16 v[16:17], v6 offset:36864
    v_mfma_f32_16x16x32_bf16 v[120:123], v[20:23], a[20:23], v[120:123]
    ds_read_b64_tr_b16 v[18:19], v6 offset:39936
    s_waitcnt lgkmcnt(8)
    v_mfma_f32_16x16x32_bf16 v[52:55], v[24:27], a[16:19], v[52:55]
    ds_read_b64_tr_b16 v[20:21], v6 offset:43008
    v_mfma_f32_16x16x32_bf16 v[76:79], v[24:27], a[20:23], v[76:79]
    ds_read_b64_tr_b16 v[22:23], v6 offset:46080
    s_waitcnt lgkmcnt(8)
    v_mfma_f32_16x16x32_bf16 v[100:103], v[28:31], a[16:19], v[100:103]
    ds_read_b64_tr_b16 v[24:25], v2 offset:36928
    v_mfma_f32_16x16x32_bf16 v[124:127], v[28:31], a[20:23], v[124:127]
    ds_read_b64_tr_b16 v[26:27], v2 offset:40000
    s_waitcnt vmcnt(6) lgkmcnt(8)
    v_mfma_f32_16x16x32_bf16 v[32:35], v[8:11], a[24:27], v[32:35]
    ds_read_b32 v5, v4 offset:16
    ds_read_b64_tr_b16 v[28:29], v2 offset:43072
    v_mfma_f32_16x16x32_bf16 v[56:59], v[8:11], a[28:31], v[56:59]
    ds_read_b64_tr_b16 v[30:31], v2 offset:46144
    s_waitcnt lgkmcnt(9)
    v_mfma_f32_16x16x32_bf16 v[80:83], v[12:15], a[24:27], v[80:83]
    v_mov_b32 v1, 18
    ds_read_b64_tr_b16 v[8:9], v6 offset:36928
    v_mfma_f32_16x16x32_bf16 v[104:107], v[12:15], a[28:31], v[104:107]
    ds_read_b64_tr_b16 v[10:11], v6 offset:40000
    s_waitcnt lgkmcnt(9)
    v_mfma_f32_16x16x32_bf16 v[36:39], v[16:19], a[24:27], v[36:39]
    ds_write_b32 v7, v1
    ds_read_b64_tr_b16 v[12:13], v6 offset:43072
    v_mfma_f32_16x16x32_bf16 v[60:63], v[16:19], a[28:31], v[60:63]
    ds_read_b64_tr_b16 v[14:15], v6 offset:46144
    s_waitcnt lgkmcnt(10)
    v_mfma_f32_16x16x32_bf16 v[84:87], v[20:23], a[24:27], v[84:87]
    buffer_load_dwordx4 a[56:59], v3, s[12:15], s59 offen offset:1024 sc1
    ds_read_b64_tr_b16 v[16:17], v2 offset:36992
    v_mfma_f32_16x16x32_bf16 v[108:111], v[20:23], a[28:31], v[108:111]
    ds_read_b64_tr_b16 v[18:19], v2 offset:40064
    s_waitcnt lgkmcnt(10)
    v_mfma_f32_16x16x32_bf16 v[40:43], v[24:27], a[24:27], v[40:43]
    buffer_load_dwordx4 a[60:63], v3, s[12:15], s62 offen offset:1024 sc1
    ds_read_b64_tr_b16 v[20:21], v2 offset:43136
    v_mfma_f32_16x16x32_bf16 v[64:67], v[24:27], a[28:31], v[64:67]
    ds_read_b64_tr_b16 v[22:23], v2 offset:46208
    s_waitcnt lgkmcnt(9)
    v_mfma_f32_16x16x32_bf16 v[88:91], v[28:31], a[24:27], v[88:91]
    s_add_u32 s59, s59, 2048
    ds_read_b64_tr_b16 v[24:25], v6 offset:36992
    v_mfma_f32_16x16x32_bf16 v[112:115], v[28:31], a[28:31], v[112:115]
    ds_read_b64_tr_b16 v[26:27], v6 offset:40064
    s_waitcnt lgkmcnt(9)
    v_mfma_f32_16x16x32_bf16 v[44:47], v[8:11], a[24:27], v[44:47]
    s_and_b32 s59, s59, 0x3fff
    ds_read_b64_tr_b16 v[28:29], v6 offset:43136
    v_mfma_f32_16x16x32_bf16 v[68:71], v[8:11], a[28:31], v[68:71]
    ds_read_b64_tr_b16 v[30:31], v6 offset:46208
    s_waitcnt lgkmcnt(8)
    v_mfma_f32_16x16x32_bf16 v[92:95], v[12:15], a[24:27], v[92:95]
    v_cmp_gt_u32 vcc, 20, v5
    s_nop 0
    s_cbranch_vccnz L_cks_51
L_ck_52:
    v_subrev_u32 v2, 98304, v2
    v_subrev_u32 v6, 98304, v6
    ds_read_b64_tr_b16 v[8:9], v2 offset:0
    v_mfma_f32_16x16x32_bf16 v[116:119], v[12:15], a[28:31], v[116:119]
    ds_read_b64_tr_b16 v[10:11], v2 offset:3072
    s_waitcnt lgkmcnt(8)
    v_mfma_f32_16x16x32_bf16 v[48:51], v[16:19], a[24:27], v[48:51]
    s_or_b32 s62, s59, 16384
    ds_read_b64_tr_b16 v[12:13], v2 offset:6144
    v_mfma_f32_16x16x32_bf16 v[72:75], v[16:19], a[28:31], v[72:75]
    ds_read_b64_tr_b16 v[14:15], v2 offset:9216
    s_waitcnt lgkmcnt(8)
    v_mfma_f32_16x16x32_bf16 v[96:99], v[20:23], a[24:27], v[96:99]
    ds_read_b64_tr_b16 v[16:17], v6 offset:0
    v_mfma_f32_16x16x32_bf16 v[120:123], v[20:23], a[28:31], v[120:123]
    ds_read_b64_tr_b16 v[18:19], v6 offset:3072
    s_waitcnt lgkmcnt(8)
    v_mfma_f32_16x16x32_bf16 v[52:55], v[24:27], a[24:27], v[52:55]
    ds_read_b64_tr_b16 v[20:21], v6 offset:6144
    v_mfma_f32_16x16x32_bf16 v[76:79], v[24:27], a[28:31], v[76:79]
    ds_read_b64_tr_b16 v[22:23], v6 offset:9216
    s_waitcnt lgkmcnt(8)
    v_mfma_f32_16x16x32_bf16 v[100:103], v[28:31], a[24:27], v[100:103]
    ds_read_b64_tr_b16 v[24:25], v2 offset:64
    v_mfma_f32_16x16x32_bf16 v[124:127], v[28:31], a[28:31], v[124:127]
    ds_read_b64_tr_b16 v[26:27], v2 offset:3136
    s_waitcnt vmcnt(6) lgkmcnt(8)
    v_mfma_f32_16x16x32_bf16 v[32:35], v[8:11], a[32:35], v[32:35]
    ds_read_b32 v5, v4 offset:16
    ds_read_b64_tr_b16 v[28:29], v2 offset:6208
    v_mfma_f32_16x16x32_bf16 v[56:59], v[8:11], a[36:39], v[56:59]
    ds_read_b64_tr_b16 v[30:31], v2 offset:9280
    s_waitcnt lgkmcnt(9)
    v_mfma_f32_16x16x32_bf16 v[80:83], v[12:15], a[32:35], v[80:83]
    v_mov_b32 v1, 19
    ds_read_b64_tr_b16 v[8:9], v6 offset:64
    v_mfma_f32_16x16x32_bf16 v[104:107], v[12:15], a[36:39], v[104:107]
    ds_read_b64_tr_b16 v[10:11], v6 offset:3136
    s_waitcnt lgkmcnt(9)
    v_mfma_f32_16x16x32_bf16 v[36:39], v[16:19], a[32:35], v[36:39]
    ds_write_b32 v7, v1
    ds_read_b64_tr_b16 v[12:13], v6 offset:6208
    v_mfma_f32_16x16x32_bf16 v[60:63], v[16:19], a[36:39], v[60:63]
    ds_read_b64_tr_b16 v[14:15], v6 offset:9280
    s_waitcnt lgkmcnt(10)
    v_mfma_f32_16x16x32_bf16 v[84:87], v[20:23], a[32:35], v[84:87]
    buffer_load_dwordx4 a[64:67], v3, s[12:15], s59 offen offset:0 sc1
    ds_read_b64_tr_b16 v[16:17], v2 offset:128
    v_mfma_f32_16x16x32_bf16 v[108:111], v[20:23], a[36:39], v[108:111]
    ds_read_b64_tr_b16 v[18:19], v2 offset:3200
    s_waitcnt lgkmcnt(10)
    v_mfma_f32_16x16x32_bf16 v[40:43], v[24:27], a[32:35], v[40:43]
    buffer_load_dwordx4 a[68:71], v3, s[12:15], s62 offen offset:0 sc1
    ds_read_b64_tr_b16 v[20:21], v2 offset:6272
    v_mfma_f32_16x16x32_bf16 v[64:67], v[24:27], a[36:39], v[64:67]
    ds_read_b64_tr_b16 v[22:23], v2 offset:9344
    s_waitcnt lgkmcnt(9)
    v_mfma_f32_16x16x32_bf16 v[88:91], v[28:31], a[32:35], v[88:91]
    ds_read_b64_tr_b16 v[24:25], v6 offset:128
    v_mfma_f32_16x16x32_bf16 v[112:115], v[28:31], a[36:39], v[112:115]
    ds_read_b64_tr_b16 v[26:27], v6 offset:3200
    s_waitcnt lgkmcnt(9)
    v_mfma_f32_16x16x32_bf16 v[44:47], v[8:11], a[32:35], v[44:47]
    ds_read_b64_tr_b16 v[28:29], v6 offset:6272
    v_mfma_f32_16x16x32_bf16 v[68:71], v[8:11], a[36:39], v[68:71]
    ds_read_b64_tr_b16 v[30:31], v6 offset:9344
    s_waitcnt lgkmcnt(8)
    v_mfma_f32_16x16x32_bf16 v[92:95], v[12:15], a[32:35], v[92:95]
    v_cmp_gt_u32 vcc, 21, v5
    s_nop 0
    s_cbranch_vccnz L_cks_55
L_ck_56:
    ds_read_b64_tr_b16 v[8:9], v2 offset:12288
    v_mfma_f32_16x16x32_bf16 v[116:119], v[12:15], a[36:39], v[116:119]
    ds_read_b64_tr_b16 v[10:11], v2 offset:15360
    s_waitcnt lgkmcnt(8)
    v_mfma_f32_16x16x32_bf16 v[48:51], v[16:19], a[32:35], v[48:51]
    ds_read_b64_tr_b16 v[12:13], v2 offset:18432
    v_mfma_f32_16x16x32_bf16 v[72:75], v[16:19], a[36:39], v[72:75]
    ds_read_b64_tr_b16 v[14:15], v2 offset:21504
    s_waitcnt lgkmcnt(8)
    v_mfma_f32_16x16x32_bf16 v[96:99], v[20:23], a[32:35], v[96:99]
    ds_read_b64_tr_b16 v[16:17], v6 offset:12288
    v_mfma_f32_16x16x32_bf16 v[120:123], v[20:23], a[36:39], v[120:123]
    ds_read_b64_tr_b16 v[18:19], v6 offset:15360
    s_waitcnt lgkmcnt(8)
    v_mfma_f32_16x16x32_bf16 v[52:55], v[24:27], a[32:35], v[52:55]
    ds_read_b64_tr_b16 v[20:21], v6 offset:18432
    v_mfma_f32_16x16x32_bf16 v[76:79], v[24:27], a[36:39], v[76:79]
    ds_read_b64_tr_b16 v[22:23], v6 offset:21504
    s_waitcnt lgkmcnt(8)
    v_mfma_f32_16x16x32_bf16 v[100:103], v[28:31], a[32:35], v[100:103]
    ds_read_b64_tr_b16 v[24:25], v2 offset:12352
    v_mfma_f32_16x16x32_bf16 v[124:127], v[28:31], a[36:39], v[124:127]
    ds_read_b64_tr_b16 v[26:27], v2 offset:15424
    s_waitcnt vmcnt(6) lgkmcnt(8)
    v_mfma_f32_16x16x32_bf16 v[32:35], v[8:11], a[40:43], v[32:35]
    ds_read_b32 v5, v4 offset:16
    ds_read_b64_tr_b16 v[28:29], v2 offset:18496
    v_mfma_f32_16x16x32_bf16 v[56:59], v[8:11], a[44:47], v[56:59]
    ds_read_b64_tr_b16 v[30:31], v2 offset:21568
    s_waitcnt lgkmcnt(9)
    v_mfma_f32_16x16x32_bf16 v[80:83], v[12:15], a[40:43], v[80:83]
    v_mov_b32 v1, 20
    ds_read_b64_tr_b16 v[8:9], v6 offset:12352
    v_mfma_f32_16x16x32_bf16 v[104:107], v[12:15], a[44:47], v[104:107]
    ds_read_b64_tr_b16 v[10:11], v6 offset:15424
    s_waitcnt lgkmcnt(9)
    v_mfma_f32_16x16x32_bf16 v[36:39], v[16:19], a[40:43], v[36:39]
    ds_write_b32 v7, v1
    ds_read_b64_tr_b16 v[12:13], v6 offset:18496
    v_mfma_f32_16x16x32_bf16 v[60:63], v[16:19], a[44:47], v[60:63]
    ds_read_b64_tr_b16 v[14:15], v6 offset:21568
    s_waitcnt lgkmcnt(10)
    v_mfma_f32_16x16x32_bf16 v[84:87], v[20:23], a[40:43], v[84:87]
    buffer_load_dwordx4 a[72:75], v3, s[12:15], s59 offen offset:1024 sc1
    ds_read_b64_tr_b16 v[16:17], v2 offset:12416
    v_mfma_f32_16x16x32_bf16 v[108:111], v[20:23], a[44:47], v[108:111]
    ds_read_b64_tr_b16 v[18:19], v2 offset:15488
    s_waitcnt lgkmcnt(10)
    v_mfma_f32_16x16x32_bf16 v[40:43], v[24:27], a[40:43], v[40:43]
    buffer_load_dwordx4 a[76:79], v3, s[12:15], s62 offen offset:1024 sc1
    ds_read_b64_tr_b16 v[20:21], v2 offset:18560
    v_mfma_f32_16x16x32_bf16 v[64:67], v[24:27], a[44:47], v[64:67]
    ds_read_b64_tr_b16 v[22:23], v2 offset:21632
    s_waitcnt lgkmcnt(9)
    v_mfma_f32_16x16x32_bf16 v[88:91], v[28:31], a[40:43], v[88:91]
    s_add_u32 s59, s59, 2048
    ds_read_b64_tr_b16 v[24:25], v6 offset:12416
    v_mfma_f32_16x16x32_bf16 v[112:115], v[28:31], a[44:47], v[112:115]
    ds_read_b64_tr_b16 v[26:27], v6 offset:15488
    s_waitcnt lgkmcnt(9)
    v_mfma_f32_16x16x32_bf16 v[44:47], v[8:11], a[40:43], v[44:47]
    s_and_b32 s59, s59, 0x3fff
    ds_read_b64_tr_b16 v[28:29], v6 offset:18560
    v_mfma_f32_16x16x32_bf16 v[68:71], v[8:11], a[44:47], v[68:71]
    ds_read_b64_tr_b16 v[30:31], v6 offset:21632
    s_waitcnt lgkmcnt(8)
    v_mfma_f32_16x16x32_bf16 v[92:95], v[12:15], a[40:43], v[92:95]
    v_cmp_gt_u32 vcc, 22, v5
    s_nop 0
    s_cbranch_vccnz L_cks_59
L_ck_60:
    ds_read_b64_tr_b16 v[8:9], v2 offset:24576
    v_mfma_f32_16x16x32_bf16 v[116:119], v[12:15], a[44:47], v[116:119]
    ds_read_b64_tr_b16 v[10:11], v2 offset:27648
    s_waitcnt lgkmcnt(8)
    v_mfma_f32_16x16x32_bf16 v[48:51], v[16:19], a[40:43], v[48:51]
    s_or_b32 s62, s59, 16384
    ds_read_b64_tr_b16 v[12:13], v2 offset:30720
    v_mfma_f32_16x16x32_bf16 v[72:75], v[16:19], a[44:47], v[72:75]
    ds_read_b64_tr_b16 v[14:15], v2 offset:33792
    s_waitcnt lgkmcnt(8)
    v_mfma_f32_16x16x32_bf16 v[96:99], v[20:23], a[40:43], v[96:99]
    ds_read_b64_tr_b16 v[16:17], v6 offset:24576
    v_mfma_f32_16x16x32_bf16 v[120:123], v[20:23], a[44:47], v[120:123]
    ds_read_b64_tr_b16 v[18:19], v6 offset:27648
    s_waitcnt lgkmcnt(8)
    v_mfma_f32_16x16x32_bf16 v[52:55], v[24:27], a[40:43], v[52:55]
    ds_read_b64_tr_b16 v[20:21], v6 offset:30720
    v_mfma_f32_16x16x32_bf16 v[76:79], v[24:27], a[44:47], v[76:79]
    ds_read_b64_tr_b16 v[22:23], v6 offset:33792
    s_waitcnt lgkmcnt(8)
    v_mfma_f32_16x16x32_bf16 v[100:103], v[28:31], a[40:43], v[100:103]
    ds_read_b64_tr_b16 v[24:25], v2 offset:24640
    v_mfma_f32_16x16x32_bf16 v[124:127], v[28:31], a[44:47], v[124:127]
    ds_read_b64_tr_b16 v[26:27], v2 offset:27712
    s_waitcnt vmcnt(6) lgkmcnt(8)
    v_mfma_f32_16x16x32_bf16 v[32:35], v[8:11], a[48:51], v[32:35]
    ds_read_b32 v5, v4 offset:16
    ds_read_b64_tr_b16 v[28:29], v2 offset:30784
    v_mfma_f32_16x16x32_bf16 v[56:59], v[8:11], a[52:55], v[56:59]
    ds_read_b64_tr_b16 v[30:31], v2 offset:33856
    s_waitcnt lgkmcnt(9)
    v_mfma_f32_16x16x32_bf16 v[80:83], v[12:15], a[48:51], v[80:83]
    v_mov_b32 v1, 21
    ds_read_b64_tr_b16 v[8:9], v6 offset:24640
    v_mfma_f32_16x16x32_bf16 v[104:107], v[12:15], a[52:55], v[104:107]
    ds_read_b64_tr_b16 v[10:11], v6 offset:27712
    s_waitcnt lgkmcnt(9)
    v_mfma_f32_16x16x32_bf16 v[36:39], v[16:19], a[48:51], v[36:39]
    ds_write_b32 v7, v1
    ds_read_b64_tr_b16 v[12:13], v6 offset:30784
    v_mfma_f32_16x16x32_bf16 v[60:63], v[16:19], a[52:55], v[60:63]
    ds_read_b64_tr_b16 v[14:15], v6 offset:33856
    s_waitcnt lgkmcnt(10)
    v_mfma_f32_16x16x32_bf16 v[84:87], v[20:23], a[48:51], v[84:87]
    buffer_load_dwordx4 a[80:83], v3, s[12:15], s59 offen offset:0 sc1
    ds_read_b64_tr_b16 v[16:17], v2 offset:24704
    v_mfma_f32_16x16x32_bf16 v[108:111], v[20:23], a[52:55], v[108:111]
    ds_read_b64_tr_b16 v[18:19], v2 offset:27776
    s_waitcnt lgkmcnt(10)
    v_mfma_f32_16x16x32_bf16 v[40:43], v[24:27], a[48:51], v[40:43]
    buffer_load_dwordx4 a[84:87], v3, s[12:15], s62 offen offset:0 sc1
    ds_read_b64_tr_b16 v[20:21], v2 offset:30848
    v_mfma_f32_16x16x32_bf16 v[64:67], v[24:27], a[52:55], v[64:67]
    ds_read_b64_tr_b16 v[22:23], v2 offset:33920
    s_waitcnt lgkmcnt(9)
    v_mfma_f32_16x16x32_bf16 v[88:91], v[28:31], a[48:51], v[88:91]
    ds_read_b64_tr_b16 v[24:25], v6 offset:24704
    v_mfma_f32_16x16x32_bf16 v[112:115], v[28:31], a[52:55], v[112:115]
    ds_read_b64_tr_b16 v[26:27], v6 offset:27776
    s_waitcnt lgkmcnt(9)
    v_mfma_f32_16x16x32_bf16 v[44:47], v[8:11], a[48:51], v[44:47]
    ds_read_b64_tr_b16 v[28:29], v6 offset:30848
    v_mfma_f32_16x16x32_bf16 v[68:71], v[8:11], a[52:55], v[68:71]
    ds_read_b64_tr_b16 v[30:31], v6 offset:33920
    s_waitcnt lgkmcnt(8)
    v_mfma_f32_16x16x32_bf16 v[92:95], v[12:15], a[48:51], v[92:95]
    v_cmp_gt_u32 vcc, 23, v5
    s_nop 0
    s_cbranch_vccnz L_cks_63
L_ck_64:
    ds_read_b64_tr_b16 v[8:9], v2 offset:36864
    v_mfma_f32_16x16x32_bf16 v[116:119], v[12:15], a[52:55], v[116:119]
    ds_read_b64_tr_b16 v[10:11], v2 offset:39936
    s_waitcnt lgkmcnt(8)
    v_mfma_f32_16x16x32_bf16 v[48:51], v[16:19], a[48:51], v[48:51]
    ds_read_b64_tr_b16 v[12:13], v2 offset:43008
    v_mfma_f32_16x16x32_bf16 v[72:75], v[16:19], a[52:55], v[72:75]
    ds_read_b64_tr_b16 v[14:15], v2 offset:46080
    s_waitcnt lgkmcnt(8)
    v_mfma_f32_16x16x32_bf16 v[96:99], v[20:23], a[48:51], v[96:99]
    ds_read_b64_tr_b16 v[16:17], v6 offset:36864
    v_mfma_f32_16x16x32_bf16 v[120:123], v[20:23], a[52:55], v[120:123]
    ds_read_b64_tr_b16 v[18:19], v6 offset:39936
    s_waitcnt lgkmcnt(8)
    v_mfma_f32_16x16x32_bf16 v[52:55], v[24:27], a[48:51], v[52:55]
    ds_read_b64_tr_b16 v[20:21], v6 offset:43008
    v_mfma_f32_16x16x32_bf16 v[76:79], v[24:27], a[52:55], v[76:79]
    ds_read_b64_tr_b16 v[22:23], v6 offset:46080
    s_waitcnt lgkmcnt(8)
    v_mfma_f32_16x16x32_bf16 v[100:103], v[28:31], a[48:51], v[100:103]
    ds_read_b64_tr_b16 v[24:25], v2 offset:36928
    v_mfma_f32_16x16x32_bf16 v[124:127], v[28:31], a[52:55], v[124:127]
    ds_read_b64_tr_b16 v[26:27], v2 offset:40000
    s_waitcnt vmcnt(6) lgkmcnt(8)
    v_mfma_f32_16x16x32_bf16 v[32:35], v[8:11], a[56:59], v[32:35]
    ds_read_b32 v5, v4 offset:16
    ds_read_b64_tr_b16 v[28:29], v2 offset:43072
    v_mfma_f32_16x16x32_bf16 v[56:59], v[8:11], a[60:63], v[56:59]
    ds_read_b64_tr_b16 v[30:31], v2 offset:46144
    s_waitcnt lgkmcnt(9)
    v_mfma_f32_16x16x32_bf16 v[80:83], v[12:15], a[56:59], v[80:83]
    v_mov_b32 v1, 22
    ds_read_b64_tr_b16 v[8:9], v6 offset:36928
    v_mfma_f32_16x16x32_bf16 v[104:107], v[12:15], a[60:63], v[104:107]
    ds_read_b64_tr_b16 v[10:11], v6 offset:40000
    s_waitcnt lgkmcnt(9)
    v_mfma_f32_16x16x32_bf16 v[36:39], v[16:19], a[56:59], v[36:39]
    ds_write_b32 v7, v1
    ds_read_b64_tr_b16 v[12:13], v6 offset:43072
    v_mfma_f32_16x16x32_bf16 v[60:63], v[16:19], a[60:63], v[60:63]
    ds_read_b64_tr_b16 v[14:15], v6 offset:46144
    s_waitcnt lgkmcnt(10)
    v_mfma_f32_16x16x32_bf16 v[84:87], v[20:23], a[56:59], v[84:87]
    buffer_load_dwordx4 a[88:91], v3, s[12:15], s59 offen offset:1024 sc1
    ds_read_b64_tr_b16 v[16:17], v2 offset:36992
    v_mfma_f32_16x16x32_bf16 v[108:111], v[20:23], a[60:63], v[108:111]
    ds_read_b64_tr_b16 v[18:19], v2 offset:40064
    s_waitcnt lgkmcnt(10)
    v_mfma_f32_16x16x32_bf16 v[40:43], v[24:27], a[56:59], v[40:43]
    buffer_load_dwordx4 a[92:95], v3, s[12:15], s62 offen offset:1024 sc1
    ds_read_b64_tr_b16 v[20:21], v2 offset:43136
    v_mfma_f32_16x16x32_bf16 v[64:67], v[24:27], a[60:63], v[64:67]
    ds_read_b64_tr_b16 v[22:23], v2 offset:46208
    s_waitcnt lgkmcnt(9)
    v_mfma_f32_16x16x32_bf16 v[88:91], v[28:31], a[56:59], v[88:91]
    s_add_u32 s59, s59, 2048
    ds_read_b64_tr_b16 v[24:25], v6 offset:36992
    v_mfma_f32_16x16x32_bf16 v[112:115], v[28:31], a[60:63], v[112:115]
    ds_read_b64_tr_b16 v[26:27], v6 offset:40064
    s_waitcnt lgkmcnt(9)
    v_mfma_f32_16x16x32_bf16 v[44:47], v[8:11], a[56:59], v[44:47]
    s_and_b32 s59, s59, 0x3fff
    ds_read_b64_tr_b16 v[28:29], v6 offset:43136
    v_mfma_f32_16x16x32_bf16 v[68:71], v[8:11], a[60:63], v[68:71]
    ds_read_b64_tr_b16 v[30:31], v6 offset:46208
    s_waitcnt lgkmcnt(8)
    v_mfma_f32_16x16x32_bf16 v[92:95], v[12:15], a[56:59], v[92:95]
    v_cmp_gt_u32 vcc, 24, v5
    s_nop 0
    s_cbranch_vccnz L_cks_67
L_ck_68:
    ds_read_b64_tr_b16 v[8:9], v2 offset:49152
    v_mfma_f32_16x16x32_bf16 v[116:119], v[12:15], a[60:63], v[116:119]
    ds_read_b64_tr_b16 v[10:11], v2 offset:52224
    s_waitcnt lgkmcnt(8)
    v_mfma_f32_16x16x32_bf16 v[48:51], v[16:19], a[56:59], v[48:51]
    s_or_b32 s62, s59, 16384
    ds_read_b64_tr_b16 v[12:13], v2 offset:55296
    v_mfma_f32_16x16x32_bf16 v[72:75], v[16:19], a[60:63], v[72:75]
    ds_read_b64_tr_b16 v[14:15], v2 offset:58368
    s_waitcnt lgkmcnt(8)
    v_mfma_f32_16x16x32_bf16 v[96:99], v[20:23], a[56:59], v[96:99]
    ds_read_b64_tr_b16 v[16:17], v6 offset:49152
    v_mfma_f32_16x16x32_bf16 v[120:123], v[20:23], a[60:63], v[120:123]
    ds_read_b64_tr_b16 v[18:19], v6 offset:52224
    s_waitcnt lgkmcnt(8)
    v_mfma_f32_16x16x32_bf16 v[52:55], v[24:27], a[56:59], v[52:55]
    ds_read_b64_tr_b16 v[20:21], v6 offset:55296
    v_mfma_f32_16x16x32_bf16 v[76:79], v[24:27], a[60:63], v[76:79]
    ds_read_b64_tr_b16 v[22:23], v6 offset:58368
    s_waitcnt lgkmcnt(8)
    v_mfma_f32_16x16x32_bf16 v[100:103], v[28:31], a[56:59], v[100:103]
    ds_read_b64_tr_b16 v[24:25], v2 offset:49216
    v_mfma_f32_16x16x32_bf16 v[124:127], v[28:31], a[60:63], v[124:127]
    ds_read_b64_tr_b16 v[26:27], v2 offset:52288
    s_waitcnt vmcnt(6) lgkmcnt(8)
    v_mfma_f32_16x16x32_bf16 v[32:35], v[8:11], a[64:67], v[32:35]
    ds_read_b32 v5, v4 offset:16
    ds_read_b64_tr_b16 v[28:29], v2 offset:55360
    v_mfma_f32_16x16x32_bf16 v[56:59], v[8:11], a[68:71], v[56:59]
    ds_read_b64_tr_b16 v[30:31], v2 offset:58432
    s_waitcnt lgkmcnt(9)
    v_mfma_f32_16x16x32_bf16 v[80:83], v[12:15], a[64:67], v[80:83]
    v_mov_b32 v1, 23
    ds_read_b64_tr_b16 v[8:9], v6 offset:49216
    v_mfma_f32_16x16x32_bf16 v[104:107], v[12:15], a[68:71], v[104:107]
    ds_read_b64_tr_b16 v[10:11], v6 offset:52288
    s_waitcnt lgkmcnt(9)
    v_mfma_f32_16x16x32_bf16 v[36:39], v[16:19], a[64:67], v[36:39]
    ds_write_b32 v7, v1
    ds_read_b64_tr_b16 v[12:13], v6 offset:55360
    v_mfma_f32_16x16x32_bf16 v[60:63], v[16:19], a[68:71], v[60:63]
    ds_read_b64_tr_b16 v[14:15], v6 offset:58432
    s_waitcnt lgkmcnt(10)
    v_mfma_f32_16x16x32_bf16 v[84:87], v[20:23], a[64:67], v[84:87]
    buffer_load_dwordx4 a[96:99], v3, s[12:15], s59 offen offset:0 sc1
    ds_read_b64_tr_b16 v[16:17], v2 offset:49280
    v_mfma_f32_16x16x32_bf16 v[108:111], v[20:23], a[68:71], v[108:111]
    ds_read_b64_tr_b16 v[18:19], v2 offset:52352
    s_waitcnt lgkmcnt(10)
    v_mfma_f32_16x16x32_bf16 v[40:43], v[24:27], a[64:67], v[40:43]
    buffer_load_dwordx4 a[100:103], v3, s[12:15], s62 offen offset:0 sc1
    ds_read_b64_tr_b16 v[20:21], v2 offset:55424
    v_mfma_f32_16x16x32_bf16 v[64:67], v[24:27], a[68:71], v[64:67]
    ds_read_b64_tr_b16 v[22:23], v2 offset:58496
    s_waitcnt lgkmcnt(9)
    v_mfma_f32_16x16x32_bf16 v[88:91], v[28:31], a[64:67], v[88:91]
    ds_read_b64_tr_b16 v[24:25], v6 offset:49280
    v_mfma_f32_16x16x32_bf16 v[112:115], v[28:31], a[68:71], v[112:115]
    ds_read_b64_tr_b16 v[26:27], v6 offset:52352
    s_waitcnt lgkmcnt(9)
    v_mfma_f32_16x16x32_bf16 v[44:47], v[8:11], a[64:67], v[44:47]
    ds_read_b64_tr_b16 v[28:29], v6 offset:55424
    v_mfma_f32_16x16x32_bf16 v[68:71], v[8:11], a[68:71], v[68:71]
    ds_read_b64_tr_b16 v[30:31], v6 offset:58496
    s_waitcnt lgkmcnt(8)
    v_mfma_f32_16x16x32_bf16 v[92:95], v[12:15], a[64:67], v[92:95]
    v_cmp_gt_u32 vcc, 25, v5
    s_nop 0
    s_cbranch_vccnz L_cks_71
L_ck_72:
    v_add_u32 v2, 61440, v2
    v_add_u32 v6, 61440, v6
    ds_read_b64_tr_b16 v[8:9], v2 offset:0
    v_mfma_f32_16x16x32_bf16 v[116:119], v[12:15], a[68:71], v[116:119]
    ds_read_b64_tr_b16 v[10:11], v2 offset:3072
    s_waitcnt lgkmcnt(8)
    v_mfma_f32_16x16x32_bf16 v[48:51], v[16:19], a[64:67], v[48:51]
    ds_read_b64_tr_b16 v[12:13], v2 offset:6144
    v_mfma_f32_16x16x32_bf16 v[72:75], v[16:19], a[68:71], v[72:75]
    ds_read_b64_tr_b16 v[14:15], v2 offset:9216
    s_waitcnt lgkmcnt(8)
    v_mfma_f32_16x16x32_bf16 v[96:99], v[20:23], a[64:67], v[96:99]
    ds_read_b64_tr_b16 v[16:17], v6 offset:0
    v_mfma_f32_16x16x32_bf16 v[120:123], v[20:23], a[68:71], v[120:123]
    ds_read_b64_tr_b16 v[18:19], v6 offset:3072
    s_waitcnt lgkmcnt(8)
    v_mfma_f32_16x16x32_bf16 v[52:55], v[24:27], a[64:67], v[52:55]
    ds_read_b64_tr_b16 v[20:21], v6 offset:6144
    v_mfma_f32_16x16x32_bf16 v[76:79], v[24:27], a[68:71], v[76:79]
    ds_read_b64_tr_b16 v[22:23], v6 offset:9216
    s_waitcnt lgkmcnt(8)
    v_mfma_f32_16x16x32_bf16 v[100:103], v[28:31], a[64:67], v[100:103]
    ds_read_b64_tr_b16 v[24:25], v2 offset:64
    v_mfma_f32_16x16x32_bf16 v[124:127], v[28:31], a[68:71], v[124:127]
    ds_read_b64_tr_b16 v[26:27], v2 offset:3136
    s_waitcnt vmcnt(6) lgkmcnt(8)
    v_mfma_f32_16x16x32_bf16 v[32:35], v[8:11], a[72:75], v[32:35]
    ds_read_b32 v5, v4 offset:16
    ds_read_b64_tr_b16 v[28:29], v2 offset:6208
    v_mfma_f32_16x16x32_bf16 v[56:59], v[8:11], a[76:79], v[56:59]
    ds_read_b64_tr_b16 v[30:31], v2 offset:9280
    s_waitcnt lgkmcnt(9)
    v_mfma_f32_16x16x32_bf16 v[80:83], v[12:15], a[72:75], v[80:83]
    v_mov_b32 v1, 24
    ds_read_b64_tr_b16 v[8:9], v6 offset:64
    v_mfma_f32_16x16x32_bf16 v[104:107], v[12:15], a[76:79], v[104:107]
    ds_read_b64_tr_b16 v[10:11], v6 offset:3136
    s_waitcnt lgkmcnt(9)
    v_mfma_f32_16x16x32_bf16 v[36:39], v[16:19], a[72:75], v[36:39]
    ds_write_b32 v7, v1
    ds_read_b64_tr_b16 v[12:13], v6 offset:6208
    v_mfma_f32_16x16x32_bf16 v[60:63], v[16:19], a[76:79], v[60:63]
    ds_read_b64_tr_b16 v[14:15], v6 offset:9280
    s_waitcnt lgkmcnt(10)
    v_mfma_f32_16x16x32_bf16 v[84:87], v[20:23], a[72:75], v[84:87]
    buffer_load_dwordx4 a[104:107], v3, s[12:15], s59 offen offset:1024 sc1
    ds_read_b64_tr_b16 v[16:17], v2 offset:128
    v_mfma_f32_16x16x32_bf16 v[108:111], v[20:23], a[76:79], v[108:111]
    ds_read_b64_tr_b16 v[18:19], v2 offset:3200
    s_waitcnt lgkmcnt(10)
    v_mfma_f32_16x16x32_bf16 v[40:43], v[24:27], a[72:75], v[40:43]
    buffer_load_dwordx4 a[108:111], v3, s[12:15], s62 offen offset:1024 sc1
    ds_read_b64_tr_b16 v[20:21], v2 offset:6272
    v_mfma_f32_16x16x32_bf16 v[64:67], v[24:27], a[76:79], v[64:67]
    ds_read_b64_tr_b16 v[22:23], v2 offset:9344
    s_waitcnt lgkmcnt(9)
    v_mfma_f32_16x16x32_bf16 v[88:91], v[28:31], a[72:75], v[88:91]
    s_add_u32 s59, s59, 2048
    ds_read_b64_tr_b16 v[24:25], v6 offset:128
    v_mfma_f32_16x16x32_bf16 v[112:115], v[28:31], a[76:79], v[112:115]
    ds_read_b64_tr_b16 v[26:27], v6 offset:3200
    s_waitcnt lgkmcnt(9)
    v_mfma_f32_16x16x32_bf16 v[44:47], v[8:11], a[72:75], v[44:47]
    s_and_b32 s59, s59, 0x3fff
    ds_read_b64_tr_b16 v[28:29], v6 offset:6272
    v_mfma_f32_16x16x32_bf16 v[68:71], v[8:11], a[76:79], v[68:71]
    ds_read_b64_tr_b16 v[30:31], v6 offset:9344
    s_waitcnt lgkmcnt(8)
    v_mfma_f32_16x16x32_bf16 v[92:95], v[12:15], a[72:75], v[92:95]
    v_cmp_gt_u32 vcc, 26, v5
    s_nop 0
    s_cbranch_vccnz L_cks_75
L_ck_76:
    ds_read_b64_tr_b16 v[8:9], v2 offset:12288
    v_mfma_f32_16x16x32_bf16 v[116:119], v[12:15], a[76:79], v[116:119]
    ds_read_b64_tr_b16 v[10:11], v2 offset:15360
    s_waitcnt lgkmcnt(8)
    v_mfma_f32_16x16x32_bf16 v[48:51], v[16:19], a[72:75], v[48:51]
    s_or_b32 s62, s59, 16384
    ds_read_b64_tr_b16 v[12:13], v2 offset:18432
    v_mfma_f32_16x16x32_bf16 v[72:75], v[16:19], a[76:79], v[72:75]
    ds_read_b64_tr_b16 v[14:15], v2 offset:21504
    s_waitcnt lgkmcnt(8)
    v_mfma_f32_16x16x32_bf16 v[96:99], v[20:23], a[72:75], v[96:99]
    ds_read_b64_tr_b16 v[16:17], v6 offset:12288
    v_mfma_f32_16x16x32_bf16 v[120:123], v[20:23], a[76:79], v[120:123]
    ds_read_b64_tr_b16 v[18:19], v6 offset:15360
    s_waitcnt lgkmcnt(8)
    v_mfma_f32_16x16x32_bf16 v[52:55], v[24:27], a[72:75], v[52:55]
    ds_read_b64_tr_b16 v[20:21], v6 offset:18432
    v_mfma_f32_16x16x32_bf16 v[76:79], v[24:27], a[76:79], v[76:79]
    ds_read_b64_tr_b16 v[22:23], v6 offset:21504
    s_waitcnt lgkmcnt(8)
    v_mfma_f32_16x16x32_bf16 v[100:103], v[28:31], a[72:75], v[100:103]
    ds_read_b64_tr_b16 v[24:25], v2 offset:12352
    v_mfma_f32_16x16x32_bf16 v[124:127], v[28:31], a[76:79], v[124:127]
    ds_read_b64_tr_b16 v[26:27], v2 offset:15424
    s_waitcnt vmcnt(6) lgkmcnt(8)
    v_mfma_f32_16x16x32_bf16 v[32:35], v[8:11], a[80:83], v[32:35]
    ds_read_b32 v5, v4 offset:16
    ds_read_b64_tr_b16 v[28:29], v2 offset:18496
    v_mfma_f32_16x16x32_bf16 v[56:59], v[8:11], a[84:87], v[56:59]
    ds_read_b64_tr_b16 v[30:31], v2 offset:21568
    s_waitcnt lgkmcnt(9)
    v_mfma_f32_16x16x32_bf16 v[80:83], v[12:15], a[80:83], v[80:83]
    v_mov_b32 v1, 25
    ds_read_b64_tr_b16 v[8:9], v6 offset:12352
    v_mfma_f32_16x16x32_bf16 v[104:107], v[12:15], a[84:87], v[104:107]
    ds_read_b64_tr_b16 v[10:11], v6 offset:15424
    s_waitcnt lgkmcnt(9)
    v_mfma_f32_16x16x32_bf16 v[36:39], v[16:19], a[80:83], v[36:39]
    ds_write_b32 v7, v1
    ds_read_b64_tr_b16 v[12:13], v6 offset:18496
    v_mfma_f32_16x16x32_bf16 v[60:63], v[16:19], a[84:87], v[60:63]
    ds_read_b64_tr_b16 v[14:15], v6 offset:21568
    s_waitcnt lgkmcnt(10)
    v_mfma_f32_16x16x32_bf16 v[84:87], v[20:23], a[80:83], v[84:87]
    buffer_load_dwordx4 a[112:115], v3, s[12:15], s59 offen offset:0 sc1
    ds_read_b64_tr_b16 v[16:17], v2 offset:12416
    v_mfma_f32_16x16x32_bf16 v[108:111], v[20:23], a[84:87], v[108:111]
    ds_read_b64_tr_b16 v[18:19], v2 offset:15488
    s_waitcnt lgkmcnt(10)
    v_mfma_f32_16x16x32_bf16 v[40:43], v[24:27], a[80:83], v[40:43]
    buffer_load_dwordx4 a[116:119], v3, s[12:15], s62 offen offset:0 sc1
    ds_read_b64_tr_b16 v[20:21], v2 offset:18560
    v_mfma_f32_16x16x32_bf16 v[64:67], v[24:27], a[84:87], v[64:67]
    ds_read_b64_tr_b16 v[22:23], v2 offset:21632
    s_waitcnt lgkmcnt(9)
    v_mfma_f32_16x16x32_bf16 v[88:91], v[28:31], a[80:83], v[88:91]
    ds_read_b64_tr_b16 v[24:25], v6 offset:12416
    v_mfma_f32_16x16x32_bf16 v[112:115], v[28:31], a[84:87], v[112:115]
    ds_read_b64_tr_b16 v[26:27], v6 offset:15488
    s_waitcnt lgkmcnt(9)
    v_mfma_f32_16x16x32_bf16 v[44:47], v[8:11], a[80:83], v[44:47]
    ds_read_b64_tr_b16 v[28:29], v6 offset:18560
    v_mfma_f32_16x16x32_bf16 v[68:71], v[8:11], a[84:87], v[68:71]
    ds_read_b64_tr_b16 v[30:31], v6 offset:21632
    s_waitcnt lgkmcnt(8)
    v_mfma_f32_16x16x32_bf16 v[92:95], v[12:15], a[80:83], v[92:95]
    v_cmp_gt_u32 vcc, 27, v5
    s_nop 0
    s_cbranch_vccnz L_cks_79
L_ck_80:
    ds_read_b64_tr_b16 v[8:9], v2 offset:24576
    v_mfma_f32_16x16x32_bf16 v[116:119], v[12:15], a[84:87], v[116:119]
    ds_read_b64_tr_b16 v[10:11], v2 offset:27648
    s_waitcnt lgkmcnt(8)
    v_mfma_f32_16x16x32_bf16 v[48:51], v[16:19], a[80:83], v[48:51]
    ds_read_b64_tr_b16 v[12:13], v2 offset:30720
    v_mfma_f32_16x16x32_bf16 v[72:75], v[16:19], a[84:87], v[72:75]
    ds_read_b64_tr_b16 v[14:15], v2 offset:33792
    s_waitcnt lgkmcnt(8)
    v_mfma_f32_16x16x32_bf16 v[96:99], v[20:23], a[80:83], v[96:99]
    ds_read_b64_tr_b16 v[16:17], v6 offset:24576
    v_mfma_f32_16x16x32_bf16 v[120:123], v[20:23], a[84:87], v[120:123]
    ds_read_b64_tr_b16 v[18:19], v6 offset:27648
    s_waitcnt lgkmcnt(8)
    v_mfma_f32_16x16x32_bf16 v[52:55], v[24:27], a[80:83], v[52:55]
    ds_read_b64_tr_b16 v[20:21], v6 offset:30720
    v_mfma_f32_16x16x32_bf16 v[76:79], v[24:27], a[84:87], v[76:79]
    ds_read_b64_tr_b16 v[22:23], v6 offset:33792
    s_waitcnt lgkmcnt(8)
    v_mfma_f32_16x16x32_bf16 v[100:103], v[28:31], a[80:83], v[100:103]
    ds_read_b64_tr_b16 v[24:25], v2 offset:24640
    v_mfma_f32_16x16x32_bf16 v[124:127], v[28:31], a[84:87], v[124:127]
    ds_read_b64_tr_b16 v[26:27], v2 offset:27712
    s_waitcnt vmcnt(6) lgkmcnt(8)
    v_mfma_f32_16x16x32_bf16 v[32:35], v[8:11], a[88:91], v[32:35]
    ds_read_b32 v5, v4 offset:16
    ds_read_b64_tr_b16 v[28:29], v2 offset:30784
    v_mfma_f32_16x16x32_bf16 v[56:59], v[8:11], a[92:95], v[56:59]
    ds_read_b64_tr_b16 v[30:31], v2 offset:33856
    s_waitcnt lgkmcnt(9)
    v_mfma_f32_16x16x32_bf16 v[80:83], v[12:15], a[88:91], v[80:83]
    v_mov_b32 v1, 26
    ds_read_b64_tr_b16 v[8:9], v6 offset:24640
    v_mfma_f32_16x16x32_bf16 v[104:107], v[12:15], a[92:95], v[104:107]
    ds_read_b64_tr_b16 v[10:11], v6 offset:27712
    s_waitcnt lgkmcnt(9)
    v_mfma_f32_16x16x32_bf16 v[36:39], v[16:19], a[88:91], v[36:39]
    ds_write_b32 v7, v1
    ds_read_b64_tr_b16 v[12:13], v6 offset:30784
    v_mfma_f32_16x16x32_bf16 v[60:63], v[16:19], a[92:95], v[60:63]
    ds_read_b64_tr_b16 v[14:15], v6 offset:33856
    s_waitcnt lgkmcnt(10)
    v_mfma_f32_16x16x32_bf16 v[84:87], v[20:23], a[88:91], v[84:87]
    buffer_load_dwordx4 a[120:123], v3, s[12:15], s59 offen offset:1024 sc1
    ds_read_b64_tr_b16 v[16:17], v2 offset:24704
    v_mfma_f32_16x16x32_bf16 v[108:111], v[20:23], a[92:95], v[108:111]
    ds_read_b64_tr_b16 v[18:19], v2 offset:27776
    s_waitcnt lgkmcnt(10)
    v_mfma_f32_16x16x32_bf16 v[40:43], v[24:27], a[88:91], v[40:43]
    buffer_load_dwordx4 a[124:127], v3, s[12:15], s62 offen offset:1024 sc1
    ds_read_b64_tr_b16 v[20:21], v2 offset:30848
    v_mfma_f32_16x16x32_bf16 v[64:67], v[24:27], a[92:95], v[64:67]
    ds_read_b64_tr_b16 v[22:23], v2 offset:33920
    s_waitcnt lgkmcnt(9)
    v_mfma_f32_16x16x32_bf16 v[88:91], v[28:31], a[88:91], v[88:91]
    ds_read_b64_tr_b16 v[24:25], v6 offset:24704
    v_mfma_f32_16x16x32_bf16 v[112:115], v[28:31], a[92:95], v[112:115]
    ds_read_b64_tr_b16 v[26:27], v6 offset:27776
    s_waitcnt lgkmcnt(9)
    v_mfma_f32_16x16x32_bf16 v[44:47], v[8:11], a[88:91], v[44:47]
    ds_read_b64_tr_b16 v[28:29], v6 offset:30848
    v_mfma_f32_16x16x32_bf16 v[68:71], v[8:11], a[92:95], v[68:71]
    ds_read_b64_tr_b16 v[30:31], v6 offset:33920
    s_waitcnt lgkmcnt(8)
    v_mfma_f32_16x16x32_bf16 v[92:95], v[12:15], a[88:91], v[92:95]
    v_cmp_gt_u32 vcc, 28, v5
    s_nop 0
    s_cbranch_vccnz L_cks_83
L_ck_84:
    ds_read_b64_tr_b16 v[8:9], v2 offset:36864
    v_mfma_f32_16x16x32_bf16 v[116:119], v[12:15], a[92:95], v[116:119]
    ds_read_b64_tr_b16 v[10:11], v2 offset:39936
    s_waitcnt lgkmcnt(8)
    v_mfma_f32_16x16x32_bf16 v[48:51], v[16:19], a[88:91], v[48:51]
    ds_read_b64_tr_b16 v[12:13], v2 offset:43008
    v_mfma_f32_16x16x32_bf16 v[72:75], v[16:19], a[92:95], v[72:75]
    ds_read_b64_tr_b16 v[14:15], v2 offset:46080
    s_waitcnt lgkmcnt(8)
    v_mfma_f32_16x16x32_bf16 v[96:99], v[20:23], a[88:91], v[96:99]
    ds_read_b64_tr_b16 v[16:17], v6 offset:36864
    v_mfma_f32_16x16x32_bf16 v[120:123], v[20:23], a[92:95], v[120:123]
    ds_read_b64_tr_b16 v[18:19], v6 offset:39936
    s_waitcnt lgkmcnt(8)
    v_mfma_f32_16x16x32_bf16 v[52:55], v[24:27], a[88:91], v[52:55]
    ds_read_b64_tr_b16 v[20:21], v6 offset:43008
    v_mfma_f32_16x16x32_bf16 v[76:79], v[24:27], a[92:95], v[76:79]
    ds_read_b64_tr_b16 v[22:23], v6 offset:46080
    s_waitcnt lgkmcnt(8)
    v_mfma_f32_16x16x32_bf16 v[100:103], v[28:31], a[88:91], v[100:103]
    ds_read_b64_tr_b16 v[24:25], v2 offset:36928
    v_mfma_f32_16x16x32_bf16 v[124:127], v[28:31], a[92:95], v[124:127]
    ds_read_b64_tr_b16 v[26:27], v2 offset:40000
    s_waitcnt vmcnt(6) lgkmcnt(8)
    v_mfma_f32_16x16x32_bf16 v[32:35], v[8:11], a[96:99], v[32:35]
    ds_read_b32 v5, v4 offset:16
    ds_read_b64_tr_b16 v[28:29], v2 offset:43072
    v_mfma_f32_16x16x32_bf16 v[56:59], v[8:11], a[100:103], v[56:59]
    ds_read_b64_tr_b16 v[30:31], v2 offset:46144
    s_waitcnt lgkmcnt(9)
    v_mfma_f32_16x16x32_bf16 v[80:83], v[12:15], a[96:99], v[80:83]
    v_mov_b32 v1, 27
    ds_read_b64_tr_b16 v[8:9], v6 offset:36928
    v_mfma_f32_16x16x32_bf16 v[104:107], v[12:15], a[100:103], v[104:107]
    ds_read_b64_tr_b16 v[10:11], v6 offset:40000
    s_waitcnt lgkmcnt(9)
    v_mfma_f32_16x16x32_bf16 v[36:39], v[16:19], a[96:99], v[36:39]
    ds_write_b32 v7, v1
    ds_read_b64_tr_b16 v[12:13], v6 offset:43072
    v_mfma_f32_16x16x32_bf16 v[60:63], v[16:19], a[100:103], v[60:63]
    ds_read_b64_tr_b16 v[14:15], v6 offset:46144
    s_waitcnt lgkmcnt(10)
    v_mfma_f32_16x16x32_bf16 v[84:87], v[20:23], a[96:99], v[84:87]
    ds_read_b64_tr_b16 v[16:17], v2 offset:36992
    v_mfma_f32_16x16x32_bf16 v[108:111], v[20:23], a[100:103], v[108:111]
    ds_read_b64_tr_b16 v[18:19], v2 offset:40064
    s_waitcnt lgkmcnt(10)
    v_mfma_f32_16x16x32_bf16 v[40:43], v[24:27], a[96:99], v[40:43]
    ds_read_b64_tr_b16 v[20:21], v2 offset:43136
    v_mfma_f32_16x16x32_bf16 v[64:67], v[24:27], a[100:103], v[64:67]
    ds_read_b64_tr_b16 v[22:23], v2 offset:46208
    s_waitcnt lgkmcnt(9)
    v_mfma_f32_16x16x32_bf16 v[88:91], v[28:31], a[96:99], v[88:91]
    ds_read_b64_tr_b16 v[24:25], v6 offset:36992
    v_mfma_f32_16x16x32_bf16 v[112:115], v[28:31], a[100:103], v[112:115]
    ds_read_b64_tr_b16 v[26:27], v6 offset:40064
    s_waitcnt lgkmcnt(9)
    v_mfma_f32_16x16x32_bf16 v[44:47], v[8:11], a[96:99], v[44:47]
    ds_read_b64_tr_b16 v[28:29], v6 offset:43136
    v_mfma_f32_16x16x32_bf16 v[68:71], v[8:11], a[100:103], v[68:71]
    ds_read_b64_tr_b16 v[30:31], v6 offset:46208
    s_waitcnt lgkmcnt(8)
    v_mfma_f32_16x16x32_bf16 v[92:95], v[12:15], a[96:99], v[92:95]
    v_cmp_gt_u32 vcc, 31, v5
    s_nop 0
    s_cbranch_vccnz L_cks_87
L_ck_88:
    v_add_u32 v2, 49152, v2
    v_add_u32 v6, 49152, v6
    ds_read_b64_tr_b16 v[8:9], v2 offset:0
    v_mfma_f32_16x16x32_bf16 v[116:119], v[12:15], a[100:103], v[116:119]
    ds_read_b64_tr_b16 v[10:11], v2 offset:3072
    s_waitcnt lgkmcnt(8)
    v_mfma_f32_16x16x32_bf16 v[48:51], v[16:19], a[96:99], v[48:51]
    ds_read_b64_tr_b16 v[12:13], v2 offset:6144
    v_mfma_f32_16x16x32_bf16 v[72:75], v[16:19], a[100:103], v[72:75]
    ds_read_b64_tr_b16 v[14:15], v2 offset:9216
    s_waitcnt lgkmcnt(8)
    v_mfma_f32_16x16x32_bf16 v[96:99], v[20:23], a[96:99], v[96:99]
    ds_read_b64_tr_b16 v[16:17], v6 offset:0
    v_mfma_f32_16x16x32_bf16 v[120:123], v[20:23], a[100:103], v[120:123]
    ds_read_b64_tr_b16 v[18:19], v6 offset:3072
    s_waitcnt lgkmcnt(8)
    v_mfma_f32_16x16x32_bf16 v[52:55], v[24:27], a[96:99], v[52:55]
    ds_read_b64_tr_b16 v[20:21], v6 offset:6144
    v_mfma_f32_16x16x32_bf16 v[76:79], v[24:27], a[100:103], v[76:79]
    ds_read_b64_tr_b16 v[22:23], v6 offset:9216
    s_waitcnt lgkmcnt(8)
    v_mfma_f32_16x16x32_bf16 v[100:103], v[28:31], a[96:99], v[100:103]
    ds_read_b64_tr_b16 v[24:25], v2 offset:12288
    v_mfma_f32_16x16x32_bf16 v[124:127], v[28:31], a[100:103], v[124:127]
    ds_read_b64_tr_b16 v[26:27], v2 offset:15360
    s_waitcnt vmcnt(4) lgkmcnt(8)
    v_mfma_f32_16x16x32_bf16 v[32:35], v[8:11], a[104:107], v[32:35]
    v_mov_b32 v1, 28
    ds_read_b64_tr_b16 v[28:29], v2 offset:18432
    v_mfma_f32_16x16x32_bf16 v[56:59], v[8:11], a[108:111], v[56:59]
    ds_read_b64_tr_b16 v[30:31], v2 offset:21504
    s_waitcnt lgkmcnt(8)
    v_mfma_f32_16x16x32_bf16 v[80:83], v[12:15], a[104:107], v[80:83]
    ds_write_b32 v7, v1
    ds_read_b64_tr_b16 v[8:9], v6 offset:12288
    v_mfma_f32_16x16x32_bf16 v[104:107], v[12:15], a[108:111], v[104:107]
    ds_read_b64_tr_b16 v[10:11], v6 offset:15360
    s_waitcnt lgkmcnt(9)
    v_mfma_f32_16x16x32_bf16 v[36:39], v[16:19], a[104:107], v[36:39]
    ds_read_b64_tr_b16 v[12:13], v6 offset:18432
    v_mfma_f32_16x16x32_bf16 v[60:63], v[16:19], a[108:111], v[60:63]
    ds_read_b64_tr_b16 v[14:15], v6 offset:21504
    s_waitcnt lgkmcnt(9)
    v_mfma_f32_16x16x32_bf16 v[84:87], v[20:23], a[104:107], v[84:87]
    ds_read_b64_tr_b16 v[16:17], v2 offset:24576
    v_mfma_f32_16x16x32_bf16 v[108:111], v[20:23], a[108:111], v[108:111]
    ds_read_b64_tr_b16 v[18:19], v2 offset:27648
    s_waitcnt vmcnt(2) lgkmcnt(9)
    v_mfma_f32_16x16x32_bf16 v[32:35], v[24:27], a[112:115], v[32:35]
    ds_read_b64_tr_b16 v[20:21], v2 offset:30720
    v_mfma_f32_16x16x32_bf16 v[56:59], v[24:27], a[116:119], v[56:59]
    ds_read_b64_tr_b16 v[22:23], v2 offset:33792
    s_waitcnt lgkmcnt(9)
    v_mfma_f32_16x16x32_bf16 v[80:83], v[28:31], a[112:115], v[80:83]
    ds_read_b64_tr_b16 v[24:25], v6 offset:24576
    v_mfma_f32_16x16x32_bf16 v[104:107], v[28:31], a[116:119], v[104:107]
    ds_read_b64_tr_b16 v[26:27], v6 offset:27648
    s_waitcnt lgkmcnt(8)
    v_mfma_f32_16x16x32_bf16 v[36:39], v[8:11], a[112:115], v[36:39]
    ds_read_b64_tr_b16 v[28:29], v6 offset:30720
    v_mfma_f32_16x16x32_bf16 v[60:63], v[8:11], a[116:119], v[60:63]
    ds_read_b64_tr_b16 v[30:31], v6 offset:33792
    s_waitcnt lgkmcnt(8)
    v_mfma_f32_16x16x32_bf16 v[84:87], v[12:15], a[112:115], v[84:87]
    ds_read_b64_tr_b16 v[8:9], v2 offset:64
    v_mfma_f32_16x16x32_bf16 v[108:111], v[12:15], a[116:119], v[108:111]
    ds_read_b64_tr_b16 v[10:11], v2 offset:3136
    s_waitcnt vmcnt(0) lgkmcnt(8)
    v_mfma_f32_16x16x32_bf16 v[32:35], v[16:19], a[120:123], v[32:35]
    ds_read_b64_tr_b16 v[12:13], v2 offset:6208
    v_mfma_f32_16x16x32_bf16 v[56:59], v[16:19], a[124:127], v[56:59]
    ds_read_b64_tr_b16 v[14:15], v2 offset:9280
    s_waitcnt lgkmcnt(8)
    v_mfma_f32_16x16x32_bf16 v[80:83], v[20:23], a[120:123], v[80:83]
    ds_read_b64_tr_b16 v[16:17], v6 offset:64
    v_mfma_f32_16x16x32_bf16 v[104:107], v[20:23], a[124:127], v[104:107]
    ds_read_b64_tr_b16 v[18:19], v6 offset:3136
    s_waitcnt lgkmcnt(8)
    v_mfma_f32_16x16x32_bf16 v[36:39], v[24:27], a[120:123], v[36:39]
    ds_read_b64_tr_b16 v[20:21], v6 offset:6208
    v_mfma_f32_16x16x32_bf16 v[60:63], v[24:27], a[124:127], v[60:63]
    ds_read_b64_tr_b16 v[22:23], v6 offset:9280
    s_waitcnt lgkmcnt(8)
    v_mfma_f32_16x16x32_bf16 v[84:87], v[28:31], a[120:123], v[84:87]
    ds_read_b64_tr_b16 v[24:25], v2 offset:12352
    v_mfma_f32_16x16x32_bf16 v[108:111], v[28:31], a[124:127], v[108:111]
    ds_read_b64_tr_b16 v[26:27], v2 offset:15424
    s_waitcnt lgkmcnt(8)
    v_mfma_f32_16x16x32_bf16 v[40:43], v[8:11], a[104:107], v[40:43]
    ds_read_b64_tr_b16 v[28:29], v2 offset:18496
    v_mfma_f32_16x16x32_bf16 v[64:67], v[8:11], a[108:111], v[64:67]
    ds_read_b64_tr_b16 v[30:31], v2 offset:21568
    s_waitcnt lgkmcnt(8)
    v_mfma_f32_16x16x32_bf16 v[88:91], v[12:15], a[104:107], v[88:91]
    v_max_f32 v32, 0, v32
    v_max_f32 v33, 0, v33
    ds_read_b64_tr_b16 v[8:9], v6 offset:12352
    v_mfma_f32_16x16x32_bf16 v[112:115], v[12:15], a[108:111], v[112:115]
    ds_read_b64_tr_b16 v[10:11], v6 offset:15424
    v_max_f32 v34, 0, v34
    v_max_f32 v35, 0, v35
    s_waitcnt lgkmcnt(8)
    v_mfma_f32_16x16x32_bf16 v[44:47], v[16:19], a[104:107], v[44:47]
    v_max_f32 v36, 0, v36
    ds_read_b64_tr_b16 v[12:13], v6 offset:18496
    v_mfma_f32_16x16x32_bf16 v[68:71], v[16:19], a[108:111], v[68:71]
    ds_read_b64_tr_b16 v[14:15], v6 offset:21568
    v_max_f32 v37, 0, v37
    v_max_f32 v38, 0, v38
    s_waitcnt lgkmcnt(8)
    v_mfma_f32_16x16x32_bf16 v[92:95], v[20:23], a[104:107], v[92:95]
    v_max_f32 v39, 0, v39
    ds_read_b64_tr_b16 v[16:17], v2 offset:24640
    v_mfma_f32_16x16x32_bf16 v[116:119], v[20:23], a[108:111], v[116:119]
    ds_read_b64_tr_b16 v[18:19], v2 offset:27712
    v_pk_mul_f32 v[32:33], v[32:33], v[80:81]
    v_pk_mul_f32 v[34:35], v[34:35], v[82:83]
    s_waitcnt lgkmcnt(8)
    v_mfma_f32_16x16x32_bf16 v[40:43], v[24:27], a[112:115], v[40:43]
    v_pk_mul_f32 v[36:37], v[36:37], v[84:85]
    ds_read_b64_tr_b16 v[20:21], v2 offset:30784
    v_mfma_f32_16x16x32_bf16 v[64:67], v[24:27], a[116:119], v[64:67]
    ds_read_b64_tr_b16 v[22:23], v2 offset:33856
    v_pk_mul_f32 v[38:39], v[38:39], v[86:87]
    v_cvt_pk_bf16_f32 v32, v32, v33
    s_waitcnt lgkmcnt(8)
    v_mfma_f32_16x16x32_bf16 v[88:91], v[28:31], a[112:115], v[88:91]
    v_cvt_pk_bf16_f32 v33, v34, v35
    ds_read_b64_tr_b16 v[24:25], v6 offset:24640
    v_mfma_f32_16x16x32_bf16 v[112:115], v[28:31], a[116:119], v[112:115]
    ds_read_b64_tr_b16 v[26:27], v6 offset:27712
    v_cvt_pk_bf16_f32 v34, v36, v37
    v_cvt_pk_bf16_f32 v35, v38, v39
    s_waitcnt lgkmcnt(8)
    v_mfma_f32_16x16x32_bf16 v[44:47], v[8:11], a[112:115], v[44:47]
    buffer_store_dwordx4 v[32:35], v3, s[12:15], s60 offen offset:0 sc1
    ds_read_b64_tr_b16 v[28:29], v6 offset:30784
    v_mfma_f32_16x16x32_bf16 v[68:71], v[8:11], a[116:119], v[68:71]
    ds_read_b64_tr_b16 v[30:31], v6 offset:33856
    v_max_f32 v56, 0, v56
    v_max_f32 v57, 0, v57
    s_waitcnt lgkmcnt(8)
    v_mfma_f32_16x16x32_bf16 v[92:95], v[12:15], a[112:115], v[92:95]
    v_max_f32 v58, 0, v58
    ds_read_b64_tr_b16 v[8:9], v2 offset:128
    v_mfma_f32_16x16x32_bf16 v[116:119], v[12:15], a[116:119], v[116:119]
    ds_read_b64_tr_b16 v[10:11], v2 offset:3200
    v_max_f32 v59, 0, v59
    v_max_f32 v60, 0, v60
    s_waitcnt lgkmcnt(8)
    v_mfma_f32_16x16x32_bf16 v[40:43], v[16:19], a[120:123], v[40:43]
    v_max_f32 v61, 0, v61
    ds_read_b64_tr_b16 v[12:13], v2 offset:6272
    v_mfma_f32_16x16x32_bf16 v[64:67], v[16:19], a[124:127], v[64:67]
    ds_read_b64_tr_b16 v[14:15], v2 offset:9344
    v_max_f32 v62, 0, v62
    v_max_f32 v63, 0, v63
    s_waitcnt lgkmcnt(8)
    v_mfma_f32_16x16x32_bf16 v[88:91], v[20:23], a[120:123], v[88:91]
    v_pk_mul_f32 v[56:57], v[56:57], v[104:105]
    ds_read_b64_tr_b16 v[16:17], v6 offset:128
    v_mfma_f32_16x16x32_bf16 v[112:115], v[20:23], a[124:127], v[112:115]
    ds_read_b64_tr_b16 v[18:19], v6 offset:3200
    v_pk_mul_f32 v[58:59], v[58:59], v[106:107]
    v_pk_mul_f32 v[60:61], v[60:61], v[108:109]
    s_waitcnt lgkmcnt(8)
    v_mfma_f32_16x16x32_bf16 v[44:47], v[24:27], a[120:123], v[44:47]
    v_pk_mul_f32 v[62:63], v[62:63], v[110:111]
    ds_read_b64_tr_b16 v[20:21], v6 offset:6272
    v_mfma_f32_16x16x32_bf16 v[68:71], v[24:27], a[124:127], v[68:71]
    ds_read_b64_tr_b16 v[22:23], v6 offset:9344
    v_cvt_pk_bf16_f32 v56, v56, v57
    v_cvt_pk_bf16_f32 v57, v58, v59
    s_waitcnt lgkmcnt(8)
    v_mfma_f32_16x16x32_bf16 v[92:95], v[28:31], a[120:123], v[92:95]
    v_cvt_pk_bf16_f32 v58, v60, v61
    ds_read_b64_tr_b16 v[24:25], v2 offset:12416
    v_mfma_f32_16x16x32_bf16 v[116:119], v[28:31], a[124:127], v[116:119]
    ds_read_b64_tr_b16 v[26:27], v2 offset:15488
    v_cvt_pk_bf16_f32 v59, v62, v63
    buffer_store_dwordx4 v[56:59], v3, s[12:15], s61 offen offset:0 sc1
    s_waitcnt lgkmcnt(8)
    v_mfma_f32_16x16x32_bf16 v[48:51], v[8:11], a[104:107], v[48:51]
    ds_read_b64_tr_b16 v[28:29], v2 offset:18560
    v_mfma_f32_16x16x32_bf16 v[72:75], v[8:11], a[108:111], v[72:75]
    ds_read_b64_tr_b16 v[30:31], v2 offset:21632
    s_waitcnt lgkmcnt(8)
    v_mfma_f32_16x16x32_bf16 v[96:99], v[12:15], a[104:107], v[96:99]
    v_max_f32 v40, 0, v40
    v_max_f32 v41, 0, v41
    ds_read_b64_tr_b16 v[8:9], v6 offset:12416
    v_mfma_f32_16x16x32_bf16 v[120:123], v[12:15], a[108:111], v[120:123]
    ds_read_b64_tr_b16 v[10:11], v6 offset:15488
    v_max_f32 v42, 0, v42
    v_max_f32 v43, 0, v43
    s_waitcnt lgkmcnt(8)
    v_mfma_f32_16x16x32_bf16 v[52:55], v[16:19], a[104:107], v[52:55]
    v_max_f32 v44, 0, v44
    ds_read_b64_tr_b16 v[12:13], v6 offset:18560
    v_mfma_f32_16x16x32_bf16 v[76:79], v[16:19], a[108:111], v[76:79]
    ds_read_b64_tr_b16 v[14:15], v6 offset:21632
    v_max_f32 v45, 0, v45
    v_max_f32 v46, 0, v46
    s_waitcnt lgkmcnt(8)
    v_mfma_f32_16x16x32_bf16 v[100:103], v[20:23], a[104:107], v[100:103]
    v_max_f32 v47, 0, v47
    ds_read_b64_tr_b16 v[16:17], v2 offset:24704
    v_mfma_f32_16x16x32_bf16 v[124:127], v[20:23], a[108:111], v[124:127]
    ds_read_b64_tr_b16 v[18:19], v2 offset:27776
    v_pk_mul_f32 v[40:41], v[40:41], v[88:89]
    v_pk_mul_f32 v[42:43], v[42:43], v[90:91]
    s_waitcnt lgkmcnt(8)
    v_mfma_f32_16x16x32_bf16 v[48:51], v[24:27], a[112:115], v[48:51]
    v_pk_mul_f32 v[44:45], v[44:45], v[92:93]
    ds_read_b64_tr_b16 v[20:21], v2 offset:30848
    v_mfma_f32_16x16x32_bf16 v[72:75], v[24:27], a[116:119], v[72:75]
    ds_read_b64_tr_b16 v[22:23], v2 offset:33920
    v_pk_mul_f32 v[46:47], v[46:47], v[94:95]
    v_cvt_pk_bf16_f32 v40, v40, v41
    s_waitcnt lgkmcnt(8)
    v_mfma_f32_16x16x32_bf16 v[96:99], v[28:31], a[112:115], v[96:99]
    v_cvt_pk_bf16_f32 v41, v42, v43
    ds_read_b64_tr_b16 v[24:25], v6 offset:24704
    v_mfma_f32_16x16x32_bf16 v[120:123], v[28:31], a[116:119], v[120:123]
    ds_read_b64_tr_b16 v[26:27], v6 offset:27776
    v_cvt_pk_bf16_f32 v42, v44, v45
    v_cvt_pk_bf16_f32 v43, v46, v47
    s_waitcnt lgkmcnt(8)
    v_mfma_f32_16x16x32_bf16 v[52:55], v[8:11], a[112:115], v[52:55]
    buffer_store_dwordx4 v[40:43], v3, s[12:15], s60 offen offset:1024 sc1
    ds_read_b64_tr_b16 v[28:29], v6 offset:30848
    v_mfma_f32_16x16x32_bf16 v[76:79], v[8:11], a[116:119], v[76:79]
    ds_read_b64_tr_b16 v[30:31], v6 offset:33920
    v_max_f32 v64, 0, v64
    v_max_f32 v65, 0, v65
    s_waitcnt lgkmcnt(8)
    v_mfma_f32_16x16x32_bf16 v[100:103], v[12:15], a[112:115], v[100:103]
    v_max_f32 v66, 0, v66
    v_mfma_f32_16x16x32_bf16 v[124:127], v[12:15], a[116:119], v[124:127]
    v_max_f32 v67, 0, v67
    v_max_f32 v68, 0, v68
    s_waitcnt lgkmcnt(6)
    v_mfma_f32_16x16x32_bf16 v[48:51], v[16:19], a[120:123], v[48:51]
    v_max_f32 v69, 0, v69
    v_mfma_f32_16x16x32_bf16 v[72:75], v[16:19], a[124:127], v[72:75]
    v_max_f32 v70, 0, v70
    v_max_f32 v71, 0, v71
    s_waitcnt lgkmcnt(4)
    v_mfma_f32_16x16x32_bf16 v[96:99], v[20:23], a[120:123], v[96:99]
    v_pk_mul_f32 v[64:65], v[64:65], v[112:113]
    v_mfma_f32_16x16x32_bf16 v[120:123], v[20:23], a[124:127], v[120:123]
    v_pk_mul_f32 v[66:67], v[66:67], v[114:115]
    v_pk_mul_f32 v[68:69], v[68:69], v[116:117]
    s_waitcnt lgkmcnt(2)
    v_mfma_f32_16x16x32_bf16 v[52:55], v[24:27], a[120:123], v[52:55]
    v_pk_mul_f32 v[70:71], v[70:71], v[118:119]
    v_mfma_f32_16x16x32_bf16 v[76:79], v[24:27], a[124:127], v[76:79]
    v_cvt_pk_bf16_f32 v64, v64, v65
    v_cvt_pk_bf16_f32 v65, v66, v67
    s_waitcnt lgkmcnt(0)
    v_mfma_f32_16x16x32_bf16 v[100:103], v[28:31], a[120:123], v[100:103]
    v_cvt_pk_bf16_f32 v66, v68, v69
    v_mfma_f32_16x16x32_bf16 v[124:127], v[28:31], a[124:127], v[124:127]
    v_cvt_pk_bf16_f32 v67, v70, v71
    buffer_store_dwordx4 v[64:67], v3, s[12:15], s61 offen offset:1024 sc1
    v_mov_b32 v1, 31
    ds_write_b32 v7, v1
    v_mov_b32 v5, s56
    v_mov_b32 v6, 0
    v_max_f32 v48, 0, v48
    v_max_f32 v49, 0, v49
    v_max_f32 v50, 0, v50
    v_max_f32 v51, 0, v51
    v_max_f32 v52, 0, v52
    v_max_f32 v53, 0, v53
    v_max_f32 v54, 0, v54
    v_max_f32 v55, 0, v55
    v_pk_mul_f32 v[48:49], v[48:49], v[96:97]
    v_pk_mul_f32 v[50:51], v[50:51], v[98:99]
    v_pk_mul_f32 v[52:53], v[52:53], v[100:101]
    v_pk_mul_f32 v[54:55], v[54:55], v[102:103]
    v_cvt_pk_bf16_f32 v48, v48, v49
    v_cvt_pk_bf16_f32 v49, v50, v51
    v_cvt_pk_bf16_f32 v50, v52, v53
    v_cvt_pk_bf16_f32 v51, v54, v55
    buffer_store_dwordx4 v[48:51], v3, s[12:15], s60 offen offset:2048 sc1
    v_max_f32 v72, 0, v72
    v_max_f32 v73, 0, v73
    v_max_f32 v74, 0, v74
    v_max_f32 v75, 0, v75
    v_max_f32 v76, 0, v76
    v_max_f32 v77, 0, v77
    v_max_f32 v78, 0, v78
    v_max_f32 v79, 0, v79
    v_pk_mul_f32 v[72:73], v[72:73], v[120:121]
    v_pk_mul_f32 v[74:75], v[74:75], v[122:123]
    v_pk_mul_f32 v[76:77], v[76:77], v[124:125]
    v_pk_mul_f32 v[78:79], v[78:79], v[126:127]
    v_cvt_pk_bf16_f32 v72, v72, v73
    v_cvt_pk_bf16_f32 v73, v74, v75
    v_cvt_pk_bf16_f32 v74, v76, v77
    v_cvt_pk_bf16_f32 v75, v78, v79
    buffer_store_dwordx4 v[72:75], v3, s[12:15], s61 offen offset:2048 sc1
    v_lshlrev_b32 v1, 4, v0
    v_and_b32 v124, 15, v0
    v_min_u32 v124, 14, v124
    v_lshlrev_b32 v124, 2, v124
    v_lshrrev_b32 v2, 2, v0
    v_lshlrev_b32 v2, 7, v2
    v_and_b32 v3, 3, v0
    v_lshl_add_u32 v2, v3, 3, v2
    v_bfe_u32 v3, v0, 3, 2
    v_lshl_add_u32 v120, v3, 5, v2
    v_xor_b32 v121, 32, v120
    v_xor_b32 v122, 64, v120
    v_xor_b32 v123, 96, v120
    s_lshl_b32 s59, s52, 12
    v_add_u32 v120, s59, v120
    v_add_u32 v121, s59, v121
    v_add_u32 v122, s59, v122
    v_add_u32 v123, s59, v123
    v_add_u32 v126, s64, v1
    s_mul_i32 s59, s52, 98304
    s_sub_u32 s59, 49152, s59
    v_add_u32 v127, s59, v126
    s_mul_i32 s62, s65, 3
    s_add_u32 s62, s62, s52
    s_lshl_b32 s62, s62, 10
    v_and_b32 v2, 15, v0
    v_lshrrev_b32 v3, 1, v2
    v_lshrrev_b32 v115, 5, v0
    v_xor_b32 v3, v3, v115
    v_lshlrev_b32 v3, 4, v3
    v_lshl_add_u32 v2, v2, 7, v3
    v_bfe_u32 v3, v0, 4, 1
    v_lshl_add_u32 v2, v3, 3, v2
    s_lshl_b32 s59, s53, 11
    s_add_u32 s59, s59, 152576
    v_add_u32 v116, s59, v2
    v_xor_b32 v117, 32, v116
    v_xor_b32 v118, 64, v116
    v_xor_b32 v119, 96, v116
    v_and_b32 v115, 48, v0
    v_add_u32 v115, 162816, v115
    ds_read_b64 v[24:25], v116
    ds_read_b64 v[26:27], v117
    ds_read_b64 v[28:29], v118
    ds_read_b64 v[30:31], v119
    v_mov_b32 v114, 0xffff0000
    s_waitcnt lgkmcnt(0)
    v_lshlrev_b32 v8, 16, v24
    v_and_b32 v9, v114, v24
    v_lshlrev_b32 v10, 16, v25
    v_and_b32 v11, v114, v25
    v_lshlrev_b32 v12, 16, v26
    v_and_b32 v13, v114, v26
    v_lshlrev_b32 v14, 16, v27
    v_and_b32 v15, v114, v27
    v_lshlrev_b32 v16, 16, v28
    v_and_b32 v17, v114, v28
    v_lshlrev_b32 v18, 16, v29
    v_and_b32 v19, v114, v29
    v_lshlrev_b32 v20, 16, v30
    v_and_b32 v21, v114, v30
    v_lshlrev_b32 v22, 16, v31
    v_and_b32 v23, v114, v31
    v_lshrrev_b32 v2, 4, v0
    v_and_b32 v3, 7, v0
    v_xor_b32 v2, v2, v3
    v_lshrrev_b32 v3, 3, v0
    v_lshlrev_b32 v3, 10, v3
    v_lshl_add_u32 v112, v2, 4, v3
    v_xor_b32 v113, 8256, v112
    v_add_u32 v125, s59, v1
    s_xor_b32 s59, s53, 1
    s_lshl_b32 s59, s59, 11
    s_add_u32 s59, s59, 152576
    v_add_u32 v26, s59, v1
    v_subrev_u32 v27, 123904, v26
    v_subrev_u32 v28, 123904, v125
    v_xor_b32 v29, 4, v7
    s_mov_b64 exec, 1
    s_cmp_eq_u32 s58, 0
    s_cbranch_scc1 L_slow_91
    s_waitcnt vmcnt(0)
    buffer_store_dword v5, v6, s[12:15], s76 offen
L_sd_92:
    s_mov_b64 exec, -1
    s_branch L_p3_done
L_p3_idle:
    v_mov_b32 v1, 31
    ds_write_b32 v7, v1
    s_mov_b32 s63, 2097152
L_lw_93:
    ds_read_b32 v1, v4 offset:16
    s_sub_u32 s63, s63, 1
    s_cbranch_scc1 L_lwd_94
    s_waitcnt lgkmcnt(0)
    v_cmp_gt_u32 vcc, 38, v1
    s_nop 0
    s_cbranch_vccz L_lwd_94
    s_sleep 8
    s_branch L_lw_93
L_lwd_94:
    v_lshlrev_b32 v1, 4, v0
    v_and_b32 v124, 15, v0
    v_min_u32 v124, 14, v124
    v_lshlrev_b32 v124, 2, v124
    v_lshrrev_b32 v2, 2, v0
    v_lshlrev_b32 v2, 7, v2
    v_and_b32 v3, 3, v0
    v_lshl_add_u32 v2, v3, 3, v2
    v_bfe_u32 v3, v0, 3, 2
    v_lshl_add_u32 v120, v3, 5, v2
    v_xor_b32 v121, 32, v120
    v_xor_b32 v122, 64, v120
    v_xor_b32 v123, 96, v120
    s_lshl_b32 s59, s52, 12
    v_add_u32 v120, s59, v120
    v_add_u32 v121, s59, v121
    v_add_u32 v122, s59, v122
    v_add_u32 v123, s59, v123
    v_add_u32 v126, s64, v1
    s_mul_i32 s59, s52, 98304
    s_sub_u32 s59, 49152, s59
    v_add_u32 v127, s59, v126
    s_mul_i32 s62, s65, 3
    s_add_u32 s62, s62, s52
    s_lshl_b32 s62, s62, 10
    v_and_b32 v2, 15, v0
    v_lshrrev_b32 v3, 1, v2
    v_lshrrev_b32 v115, 5, v0
    v_xor_b32 v3, v3, v115
    v_lshlrev_b32 v3, 4, v3
    v_lshl_add_u32 v2, v2, 7, v3
    v_bfe_u32 v3, v0, 4, 1
    v_lshl_add_u32 v2, v3, 3, v2
    s_lshl_b32 s59, s53, 11
    s_add_u32 s59, s59, 152576
    v_add_u32 v116, s59, v2
    v_xor_b32 v117, 32, v116
    v_xor_b32 v118, 64, v116
    v_xor_b32 v119, 96, v116
    v_and_b32 v115, 48, v0
    v_add_u32 v115, 162816, v115
    ds_read_b64 v[24:25], v116
    ds_read_b64 v[26:27], v117
    ds_read_b64 v[28:29], v118
    ds_read_b64 v[30:31], v119
    v_mov_b32 v114, 0xffff0000
    s_waitcnt lgkmcnt(0)
    v_lshlrev_b32 v8, 16, v24
    v_and_b32 v9, v114, v24
    v_lshlrev_b32 v10, 16, v25
    v_and_b32 v11, v114, v25
    v_lshlrev_b32 v12, 16, v26
    v_and_b32 v13, v114, v26
    v_lshlrev_b32 v14, 16, v27
    v_and_b32 v15, v114, v27
    v_lshlrev_b32 v16, 16, v28
    v_and_b32 v17, v114, v28
    v_lshlrev_b32 v18, 16, v29
    v_and_b32 v19, v114, v29
    v_lshlrev_b32 v20, 16, v30
    v_and_b32 v21, v114, v30
    v_lshlrev_b32 v22, 16, v31
    v_and_b32 v23, v114, v31
    v_lshrrev_b32 v2, 4, v0
    v_and_b32 v3, 7, v0
    v_xor_b32 v2, v2, v3
    v_lshrrev_b32 v3, 3, v0
    v_lshlrev_b32 v3, 10, v3
    v_lshl_add_u32 v112, v2, 4, v3
    v_xor_b32 v113, 8256, v112
    v_add_u32 v125, s59, v1
    s_xor_b32 s59, s53, 1
    s_lshl_b32 s59, s59, 11
    s_add_u32 s59, s59, 152576
    v_add_u32 v26, s59, v1
    v_subrev_u32 v27, 123904, v26
    v_subrev_u32 v28, 123904, v125
    v_xor_b32 v29, 4, v7
L_p3_done:
    s_mov_b32 s63, 2097152
L_lw_95:
    ds_read_b32 v24, v4 offset:16
    s_sub_u32 s63, s63, 1
    s_cbranch_scc1 L_lwd_96
    s_waitcnt lgkmcnt(0)
    v_cmp_gt_u32 vcc, 33, v24
    s_nop 0
    s_cbranch_vccnz L_lw_95
L_lwd_96:
    ds_read_b64_tr_b16 v[64:65], v120 offset:0
    ds_read_b64_tr_b16 v[66:67], v120 offset:2048
    ds_read_b64_tr_b16 v[68:69], v121 offset:0
    ds_read_b64_tr_b16 v[70:71], v121 offset:2048
    ds_read_b64_tr_b16 v[72:73], v122 offset:0
    ds_read_b64_tr_b16 v[74:75], v122 offset:2048
    ds_read_b64_tr_b16 v[76:77], v123 offset:0
    ds_read_b64_tr_b16 v[78:79], v123 offset:2048
    ds_read_b64_tr_b16 v[80:81], v120 offset:8192
    ds_read_b64_tr_b16 v[82:83], v120 offset:10240
    ds_read_b64_tr_b16 v[84:85], v121 offset:8192
    ds_read_b64_tr_b16 v[86:87], v121 offset:10240
    ds_read_b64_tr_b16 v[88:89], v122 offset:8192
    ds_read_b64_tr_b16 v[90:91], v122 offset:10240
    ds_read_b64_tr_b16 v[92:93], v123 offset:8192
    ds_read_b64_tr_b16 v[94:95], v123 offset:10240
    s_mov_b32 s63, 262144
L_poll_97:
    buffer_load_dword v25, v124, s[12:15], s77 offen sc1
    s_sub_u32 s63, s63, 1
    s_cbranch_scc1 L_pd_98
    s_waitcnt vmcnt(0)
    v_cmp_ne_u32 vcc, s56, v25
    s_nop 0
    s_cbranch_vccnz L_poll_97
L_pd_98:
    buffer_load_dwordx4 a[0:3], v126, s[12:15], s62 offen sc1
    buffer_load_dwordx4 a[4:7], v127, s[12:15], s62 offen sc1
    s_add_u32 s62, s62, 2048
    s_sub_u32 s59, s62, 43008
    s_cselect_b32 s62, s62, s59
    buffer_load_dwordx4 a[8:11], v126, s[12:15], s62 offen sc1
    buffer_load_dwordx4 a[12:15], v127, s[12:15], s62 offen sc1
    s_add_u32 s62, s62, 2048
    s_sub_u32 s59, s62, 43008
    s_cselect_b32 s62, s62, s59
    buffer_load_dwordx4 a[16:19], v126, s[12:15], s62 offen sc1
    buffer_load_dwordx4 a[20:23], v127, s[12:15], s62 offen sc1
    s_add_u32 s62, s62, 2048
    s_sub_u32 s59, s62, 43008
    s_cselect_b32 s62, s62, s59
    buffer_load_dwordx4 a[24:27], v126, s[12:15], s62 offen sc1
    buffer_load_dwordx4 a[28:31], v127, s[12:15], s62 offen sc1
    s_add_u32 s62, s62, 2048
    s_sub_u32 s59, s62, 43008
    s_cselect_b32 s62, s62, s59
    s_waitcnt vmcnt(6) lgkmcnt(8)
    v_mfma_f32_16x16x32_bf16 v[48:51], v[64:67], a[4:7], 0
    buffer_load_dwordx4 a[32:35], v126, s[12:15], s62 offen sc1
    buffer_load_dwordx4 a[36:39], v127, s[12:15], s62 offen sc1
    v_mfma_f32_16x16x32_bf16 v[52:55], v[68:71], a[4:7], 0
    ds_read_b64_tr_b16 v[96:97], v120 offset:16384
    ds_read_b64_tr_b16 v[98:99], v120 offset:18432
    v_mfma_f32_16x16x32_bf16 v[56:59], v[72:75], a[4:7], 0
    ds_read_b64_tr_b16 v[100:101], v121 offset:16384
    ds_read_b64_tr_b16 v[102:103], v121 offset:18432
    v_mfma_f32_16x16x32_bf16 v[60:63], v[76:79], a[4:7], 0
    ds_read_b64_tr_b16 v[104:105], v122 offset:16384
    ds_read_b64_tr_b16 v[106:107], v122 offset:18432
    v_mfma_f32_16x16x32_bf16 v[32:35], v[64:67], a[0:3], 0
    ds_read_b64_tr_b16 v[108:109], v123 offset:16384
    ds_read_b64_tr_b16 v[110:111], v123 offset:18432
    v_mfma_f32_16x16x32_bf16 v[36:39], v[68:71], a[0:3], 0
    s_add_u32 s62, s62, 2048
    v_mfma_f32_16x16x32_bf16 v[40:43], v[72:75], a[0:3], 0
    s_sub_u32 s59, s62, 43008
    v_mfma_f32_16x16x32_bf16 v[44:47], v[76:79], a[0:3], 0
    s_cselect_b32 s62, s62, s59
    s_waitcnt vmcnt(6) lgkmcnt(8)
    v_mfma_f32_16x16x32_bf16 v[48:51], v[80:83], a[12:15], v[48:51]
    v_cmp_gt_u32 vcc, 35, v24
    s_nop 0
    s_cbranch_vccnz L_cks_99
L_ck_100:
    v_mfma_f32_16x16x32_bf16 v[52:55], v[84:87], a[12:15], v[52:55]
    buffer_load_dwordx4 a[40:43], v126, s[12:15], s62 offen sc1
    buffer_load_dwordx4 a[44:47], v127, s[12:15], s62 offen sc1
    v_mfma_f32_16x16x32_bf16 v[56:59], v[88:91], a[12:15], v[56:59]
    v_mov_b32 v25, 32
    ds_write_b32 v7, v25
    v_mfma_f32_16x16x32_bf16 v[60:63], v[92:95], a[12:15], v[60:63]
    ds_read_b64_tr_b16 v[64:65], v120 offset:24576
    ds_read_b64_tr_b16 v[66:67], v120 offset:26624
    v_mfma_f32_16x16x32_bf16 v[32:35], v[80:83], a[8:11], v[32:35]
    ds_read_b64_tr_b16 v[68:69], v121 offset:24576
    ds_read_b64_tr_b16 v[70:71], v121 offset:26624
    v_mfma_f32_16x16x32_bf16 v[36:39], v[84:87], a[8:11], v[36:39]
    ds_read_b64_tr_b16 v[72:73], v122 offset:24576
    ds_read_b64_tr_b16 v[74:75], v122 offset:26624
    v_mfma_f32_16x16x32_bf16 v[40:43], v[88:91], a[8:11], v[40:43]
    ds_read_b64_tr_b16 v[76:77], v123 offset:24576
    ds_read_b64_tr_b16 v[78:79], v123 offset:26624
    v_mfma_f32_16x16x32_bf16 v[44:47], v[92:95], a[8:11], v[44:47]
    s_add_u32 s62, s62, 2048
    s_sub_u32 s59, s62, 43008
    s_cselect_b32 s62, s62, s59
    s_waitcnt vmcnt(6) lgkmcnt(9)
    v_mfma_f32_16x16x32_bf16 v[48:51], v[96:99], a[20:23], v[48:51]
    buffer_load_dwordx4 a[48:51], v126, s[12:15], s62 offen sc1
    buffer_load_dwordx4 a[52:55], v127, s[12:15], s62 offen sc1
    v_mfma_f32_16x16x32_bf16 v[52:55], v[100:103], a[20:23], v[52:55]
    v_mov_b32 v25, 33
    ds_write_b32 v7, v25
    v_mfma_f32_16x16x32_bf16 v[56:59], v[104:107], a[20:23], v[56:59]
    ds_read_b32 v24, v4 offset:16
    ds_read_b64_tr_b16 v[80:81], v120 offset:32768
    v_mfma_f32_16x16x32_bf16 v[60:63], v[108:111], a[20:23], v[60:63]
    ds_read_b64_tr_b16 v[82:83], v120 offset:34816
    ds_read_b64_tr_b16 v[84:85], v121 offset:32768
    v_mfma_f32_16x16x32_bf16 v[32:35], v[96:99], a[16:19], v[32:35]
    ds_read_b64_tr_b16 v[86:87], v121 offset:34816
    ds_read_b64_tr_b16 v[88:89], v122 offset:32768
    v_mfma_f32_16x16x32_bf16 v[36:39], v[100:103], a[16:19], v[36:39]
    ds_read_b64_tr_b16 v[90:91], v122 offset:34816
    ds_read_b64_tr_b16 v[92:93], v123 offset:32768
    v_mfma_f32_16x16x32_bf16 v[40:43], v[104:107], a[16:19], v[40:43]
    ds_read_b64_tr_b16 v[94:95], v123 offset:34816
    s_add_u32 s62, s62, 2048
    v_mfma_f32_16x16x32_bf16 v[44:47], v[108:111], a[16:19], v[44:47]
    s_sub_u32 s59, s62, 43008
    s_cselect_b32 s62, s62, s59
    s_waitcnt vmcnt(6) lgkmcnt(10)
    v_mfma_f32_16x16x32_bf16 v[48:51], v[64:67], a[28:31], v[48:51]
    buffer_load_dwordx4 a[56:59], v126, s[12:15], s62 offen sc1
    buffer_load_dwordx4 a[60:63], v127, s[12:15], s62 offen sc1
    v_mfma_f32_16x16x32_bf16 v[52:55], v[68:71], a[28:31], v[52:55]
    ds_read_b64_tr_b16 v[96:97], v120 offset:40960
    ds_read_b64_tr_b16 v[98:99], v120 offset:43008
    v_mfma_f32_16x16x32_bf16 v[56:59], v[72:75], a[28:31], v[56:59]
    ds_read_b64_tr_b16 v[100:101], v121 offset:40960
    ds_read_b64_tr_b16 v[102:103], v121 offset:43008
    v_mfma_f32_16x16x32_bf16 v[60:63], v[76:79], a[28:31], v[60:63]
    ds_read_b64_tr_b16 v[104:105], v122 offset:40960
    ds_read_b64_tr_b16 v[106:107], v122 offset:43008
    v_mfma_f32_16x16x32_bf16 v[32:35], v[64:67], a[24:27], v[32:35]
    ds_read_b64_tr_b16 v[108:109], v123 offset:40960
    ds_read_b64_tr_b16 v[110:111], v123 offset:43008
    v_mfma_f32_16x16x32_bf16 v[36:39], v[68:71], a[24:27], v[36:39]
    s_add_u32 s62, s62, 2048
    v_mfma_f32_16x16x32_bf16 v[40:43], v[72:75], a[24:27], v[40:43]
    s_sub_u32 s59, s62, 43008
    v_mfma_f32_16x16x32_bf16 v[44:47], v[76:79], a[24:27], v[44:47]
    s_cselect_b32 s62, s62, s59
    s_waitcnt vmcnt(6) lgkmcnt(8)
    v_mfma_f32_16x16x32_bf16 v[48:51], v[80:83], a[36:39], v[48:51]
    v_cmp_gt_u32 vcc, 37, v24
    s_nop 0
    s_cbranch_vccnz L_cks_103
L_ck_104:
    v_mfma_f32_16x16x32_bf16 v[52:55], v[84:87], a[36:39], v[52:55]
    buffer_load_dwordx4 a[64:67], v126, s[12:15], s62 offen sc1
    buffer_load_dwordx4 a[68:71], v127, s[12:15], s62 offen sc1
    v_mfma_f32_16x16x32_bf16 v[56:59], v[88:91], a[36:39], v[56:59]
    v_mov_b32 v25, 34
    ds_write_b32 v7, v25
    v_mfma_f32_16x16x32_bf16 v[60:63], v[92:95], a[36:39], v[60:63]
    ds_read_b64_tr_b16 v[64:65], v120 offset:49152
    ds_read_b64_tr_b16 v[66:67], v120 offset:51200
    v_mfma_f32_16x16x32_bf16 v[32:35], v[80:83], a[32:35], v[32:35]
    ds_read_b64_tr_b16 v[68:69], v121 offset:49152
    ds_read_b64_tr_b16 v[70:71], v121 offset:51200
    v_mfma_f32_16x16x32_bf16 v[36:39], v[84:87], a[32:35], v[36:39]
    ds_read_b64_tr_b16 v[72:73], v122 offset:49152
    ds_read_b64_tr_b16 v[74:75], v122 offset:51200
    v_mfma_f32_16x16x32_bf16 v[40:43], v[88:91], a[32:35], v[40:43]
    ds_read_b64_tr_b16 v[76:77], v123 offset:49152
    ds_read_b64_tr_b16 v[78:79], v123 offset:51200
    v_mfma_f32_16x16x32_bf16 v[44:47], v[92:95], a[32:35], v[44:47]
    s_add_u32 s62, s62, 2048
    s_sub_u32 s59, s62, 43008
    s_cselect_b32 s62, s62, s59
    s_waitcnt vmcnt(6) lgkmcnt(9)
    v_mfma_f32_16x16x32_bf16 v[48:51], v[96:99], a[44:47], v[48:51]
    buffer_load_dwordx4 a[72:75], v126, s[12:15], s62 offen sc1
    buffer_load_dwordx4 a[76:79], v127, s[12:15], s62 offen sc1
    v_mfma_f32_16x16x32_bf16 v[52:55], v[100:103], a[44:47], v[52:55]
    ds_read_b32 v24, v4 offset:16
    ds_read_b64_tr_b16 v[80:81], v120 offset:57344
    v_mfma_f32_16x16x32_bf16 v[56:59], v[104:107], a[44:47], v[56:59]
    ds_read_b64_tr_b16 v[82:83], v120 offset:59392
    ds_read_b64_tr_b16 v[84:85], v121 offset:57344
    v_mfma_f32_16x16x32_bf16 v[60:63], v[108:111], a[44:47], v[60:63]
    ds_read_b64_tr_b16 v[86:87], v121 offset:59392
    ds_read_b64_tr_b16 v[88:89], v122 offset:57344
    v_mfma_f32_16x16x32_bf16 v[32:35], v[96:99], a[40:43], v[32:35]
    ds_read_b64_tr_b16 v[90:91], v122 offset:59392
    ds_read_b64_tr_b16 v[92:93], v123 offset:57344
    v_mfma_f32_16x16x32_bf16 v[36:39], v[100:103], a[40:43], v[36:39]
    ds_read_b64_tr_b16 v[94:95], v123 offset:59392
    s_add_u32 s62, s62, 2048
    v_mfma_f32_16x16x32_bf16 v[40:43], v[104:107], a[40:43], v[40:43]
    s_sub_u32 s59, s62, 43008
    v_mfma_f32_16x16x32_bf16 v[44:47], v[108:111], a[40:43], v[44:47]
    s_cselect_b32 s62, s62, s59
    s_waitcnt vmcnt(6) lgkmcnt(9)
    v_mfma_f32_16x16x32_bf16 v[48:51], v[64:67], a[52:55], v[48:51]
    buffer_load_dwordx4 a[80:83], v126, s[12:15], s62 offen sc1
    buffer_load_dwordx4 a[84:87], v127, s[12:15], s62 offen sc1
    v_mfma_f32_16x16x32_bf16 v[52:55], v[68:71], a[52:55], v[52:55]
    v_add_u32 v120, 65536, v120
    v_add_u32 v121, 65536, v121
    v_mfma_f32_16x16x32_bf16 v[56:59], v[72:75], a[52:55], v[56:59]
    v_add_u32 v122, 65536, v122
    v_add_u32 v123, 65536, v123
    v_mfma_f32_16x16x32_bf16 v[60:63], v[76:79], a[52:55], v[60:63]
    ds_read_b64_tr_b16 v[96:97], v120 offset:0
    ds_read_b64_tr_b16 v[98:99], v120 offset:2048
    v_mfma_f32_16x16x32_bf16 v[32:35], v[64:67], a[48:51], v[32:35]
    ds_read_b64_tr_b16 v[100:101], v121 offset:0
    ds_read_b64_tr_b16 v[102:103], v121 offset:2048
    v_mfma_f32_16x16x32_bf16 v[36:39], v[68:71], a[48:51], v[36:39]
    ds_read_b64_tr_b16 v[104:105], v122 offset:0
    ds_read_b64_tr_b16 v[106:107], v122 offset:2048
    v_mfma_f32_16x16x32_bf16 v[40:43], v[72:75], a[48:51], v[40:43]
    ds_read_b64_tr_b16 v[108:109], v123 offset:0
    ds_read_b64_tr_b16 v[110:111], v123 offset:2048
    v_mfma_f32_16x16x32_bf16 v[44:47], v[76:79], a[48:51], v[44:47]
    s_add_u32 s62, s62, 2048
    s_sub_u32 s59, s62, 43008
    s_cselect_b32 s62, s62, s59
    s_waitcnt vmcnt(6) lgkmcnt(8)
    v_mfma_f32_16x16x32_bf16 v[48:51], v[80:83], a[60:63], v[48:51]
    v_cmp_gt_u32 vcc, 39, v24
    s_nop 0
    s_cbranch_vccnz L_cks_107
L_ck_108:
    v_mfma_f32_16x16x32_bf16 v[52:55], v[84:87], a[60:63], v[52:55]
    buffer_load_dwordx4 a[88:91], v126, s[12:15], s62 offen sc1
    buffer_load_dwordx4 a[92:95], v127, s[12:15], s62 offen sc1
    v_mfma_f32_16x16x32_bf16 v[56:59], v[88:91], a[60:63], v[56:59]
    ds_read_b64_tr_b16 v[64:65], v120 offset:8192
    ds_read_b64_tr_b16 v[66:67], v120 offset:10240
    v_mfma_f32_16x16x32_bf16 v[60:63], v[92:95], a[60:63], v[60:63]
    ds_read_b64_tr_b16 v[68:69], v121 offset:8192
    ds_read_b64_tr_b16 v[70:71], v121 offset:10240
    v_mfma_f32_16x16x32_bf16 v[32:35], v[80:83], a[56:59], v[32:35]
    ds_read_b64_tr_b16 v[72:73], v122 offset:8192
    ds_read_b64_tr_b16 v[74:75], v122 offset:10240
    v_mfma_f32_16x16x32_bf16 v[36:39], v[84:87], a[56:59], v[36:39]
    ds_read_b64_tr_b16 v[76:77], v123 offset:8192
    ds_read_b64_tr_b16 v[78:79], v123 offset:10240
    v_mfma_f32_16x16x32_bf16 v[40:43], v[88:91], a[56:59], v[40:43]
    s_add_u32 s62, s62, 2048
    s_sub_u32 s59, s62, 43008
    v_mfma_f32_16x16x32_bf16 v[44:47], v[92:95], a[56:59], v[44:47]
    s_cselect_b32 s62, s62, s59
    s_waitcnt vmcnt(6) lgkmcnt(8)
    v_mfma_f32_16x16x32_bf16 v[48:51], v[96:99], a[68:71], v[48:51]
    buffer_load_dwordx4 a[96:99], v126, s[12:15], s62 offen sc1
    buffer_load_dwordx4 a[100:103], v127, s[12:15], s62 offen sc1
    v_mfma_f32_16x16x32_bf16 v[52:55], v[100:103], a[68:71], v[52:55]
    ds_read_b32 v24, v4 offset:16
    ds_read_b64_tr_b16 v[80:81], v120 offset:16384
    v_mfma_f32_16x16x32_bf16 v[56:59], v[104:107], a[68:71], v[56:59]
    ds_read_b64_tr_b16 v[82:83], v120 offset:18432
    ds_read_b64_tr_b16 v[84:85], v121 offset:16384
    v_mfma_f32_16x16x32_bf16 v[60:63], v[108:111], a[68:71], v[60:63]
    ds_read_b64_tr_b16 v[86:87], v121 offset:18432
    ds_read_b64_tr_b16 v[88:89], v122 offset:16384
    v_mfma_f32_16x16x32_bf16 v[32:35], v[96:99], a[64:67], v[32:35]
    ds_read_b64_tr_b16 v[90:91], v122 offset:18432
    ds_read_b64_tr_b16 v[92:93], v123 offset:16384
    v_mfma_f32_16x16x32_bf16 v[36:39], v[100:103], a[64:67], v[36:39]
    ds_read_b64_tr_b16 v[94:95], v123 offset:18432
    s_add_u32 s62, s62, 2048
    v_mfma_f32_16x16x32_bf16 v[40:43], v[104:107], a[64:67], v[40:43]
    s_sub_u32 s59, s62, 43008
    v_mfma_f32_16x16x32_bf16 v[44:47], v[108:111], a[64:67], v[44:47]
    s_cselect_b32 s62, s62, s59
    s_waitcnt vmcnt(6) lgkmcnt(9)
    v_mfma_f32_16x16x32_bf16 v[48:51], v[64:67], a[76:79], v[48:51]
    buffer_load_dwordx4 a[104:107], v126, s[12:15], s62 offen sc1
    buffer_load_dwordx4 a[108:111], v127, s[12:15], s62 offen sc1
    v_mfma_f32_16x16x32_bf16 v[52:55], v[68:71], a[76:79], v[52:55]
    ds_read_b64_tr_b16 v[96:97], v120 offset:24576
    ds_read_b64_tr_b16 v[98:99], v120 offset:26624
    v_mfma_f32_16x16x32_bf16 v[56:59], v[72:75], a[76:79], v[56:59]
    ds_read_b64_tr_b16 v[100:101], v121 offset:24576
    ds_read_b64_tr_b16 v[102:103], v121 offset:26624
    v_mfma_f32_16x16x32_bf16 v[60:63], v[76:79], a[76:79], v[60:63]
    ds_read_b64_tr_b16 v[104:105], v122 offset:24576
    ds_read_b64_tr_b16 v[106:107], v122 offset:26624
    v_mfma_f32_16x16x32_bf16 v[32:35], v[64:67], a[72:75], v[32:35]
    ds_read_b64_tr_b16 v[108:109], v123 offset:24576
    ds_read_b64_tr_b16 v[110:111], v123 offset:26624
    v_mfma_f32_16x16x32_bf16 v[36:39], v[68:71], a[72:75], v[36:39]
    s_add_u32 s62, s62, 2048
    v_mfma_f32_16x16x32_bf16 v[40:43], v[72:75], a[72:75], v[40:43]
    s_sub_u32 s59, s62, 43008
    v_mfma_f32_16x16x32_bf16 v[44:47], v[76:79], a[72:75], v[44:47]
    s_cselect_b32 s62, s62, s59
    s_waitcnt vmcnt(6) lgkmcnt(8)
    v_mfma_f32_16x16x32_bf16 v[48:51], v[80:83], a[84:87], v[48:51]
    v_cmp_gt_u32 vcc, 41, v24
    s_nop 0
    s_cbranch_vccnz L_cks_111
L_ck_112:
    v_mfma_f32_16x16x32_bf16 v[52:55], v[84:87], a[84:87], v[52:55]
    buffer_load_dwordx4 a[112:115], v126, s[12:15], s62 offen sc1
    buffer_load_dwordx4 a[116:119], v127, s[12:15], s62 offen sc1
    v_mfma_f32_16x16x32_bf16 v[56:59], v[88:91], a[84:87], v[56:59]
    ds_read_b64_tr_b16 v[64:65], v120 offset:32768
    ds_read_b64_tr_b16 v[66:67], v120 offset:34816
    v_mfma_f32_16x16x32_bf16 v[60:63], v[92:95], a[84:87], v[60:63]
    ds_read_b64_tr_b16 v[68:69], v121 offset:32768
    ds_read_b64_tr_b16 v[70:71], v121 offset:34816
    v_mfma_f32_16x16x32_bf16 v[32:35], v[80:83], a[80:83], v[32:35]
    ds_read_b64_tr_b16 v[72:73], v122 offset:32768
    ds_read_b64_tr_b16 v[74:75], v122 offset:34816
    v_mfma_f32_16x16x32_bf16 v[36:39], v[84:87], a[80:83], v[36:39]
    ds_read_b64_tr_b16 v[76:77], v123 offset:32768
    ds_read_b64_tr_b16 v[78:79], v123 offset:34816
    v_mfma_f32_16x16x32_bf16 v[40:43], v[88:91], a[80:83], v[40:43]
    s_add_u32 s62, s62, 2048
    s_sub_u32 s59, s62, 43008
    v_mfma_f32_16x16x32_bf16 v[44:47], v[92:95], a[80:83], v[44:47]
    s_cselect_b32 s62, s62, s59
    s_waitcnt vmcnt(6) lgkmcnt(8)
    v_mfma_f32_16x16x32_bf16 v[48:51], v[96:99], a[92:95], v[48:51]
    buffer_load_dwordx4 a[120:123], v126, s[12:15], s62 offen sc1
    buffer_load_dwordx4 a[124:127], v127, s[12:15], s62 offen sc1
    v_mfma_f32_16x16x32_bf16 v[52:55], v[100:103], a[92:95], v[52:55]
    ds_read_b32 v24, v4 offset:16
    ds_read_b64_tr_b16 v[80:81], v120 offset:40960
    v_mfma_f32_16x16x32_bf16 v[56:59], v[104:107], a[92:95], v[56:59]
    ds_read_b64_tr_b16 v[82:83], v120 offset:43008
    ds_read_b64_tr_b16 v[84:85], v121 offset:40960
    v_mfma_f32_16x16x32_bf16 v[60:63], v[108:111], a[92:95], v[60:63]
    ds_read_b64_tr_b16 v[86:87], v121 offset:43008
    ds_read_b64_tr_b16 v[88:89], v122 offset:40960
    v_mfma_f32_16x16x32_bf16 v[32:35], v[96:99], a[88:91], v[32:35]
    ds_read_b64_tr_b16 v[90:91], v122 offset:43008
    ds_read_b64_tr_b16 v[92:93], v123 offset:40960
    v_mfma_f32_16x16x32_bf16 v[36:39], v[100:103], a[88:91], v[36:39]
    ds_read_b64_tr_b16 v[94:95], v123 offset:43008
    s_add_u32 s62, s62, 2048
    v_mfma_f32_16x16x32_bf16 v[40:43], v[104:107], a[88:91], v[40:43]
    s_sub_u32 s59, s62, 43008
    v_mfma_f32_16x16x32_bf16 v[44:47], v[108:111], a[88:91], v[44:47]
    s_cselect_b32 s62, s62, s59
    s_waitcnt vmcnt(6) lgkmcnt(9)
    v_mfma_f32_16x16x32_bf16 v[48:51], v[64:67], a[100:103], v[48:51]
    buffer_load_dwordx4 a[0:3], v126, s[12:15], s62 offen sc1
    buffer_load_dwordx4 a[4:7], v127, s[12:15], s62 offen sc1
    v_mfma_f32_16x16x32_bf16 v[52:55], v[68:71], a[100:103], v[52:55]
    ds_read_b64_tr_b16 v[96:97], v120 offset:49152
    ds_read_b64_tr_b16 v[98:99], v120 offset:51200
    v_mfma_f32_16x16x32_bf16 v[56:59], v[72:75], a[100:103], v[56:59]
    ds_read_b64_tr_b16 v[100:101], v121 offset:49152
    ds_read_b64_tr_b16 v[102:103], v121 offset:51200
    v_mfma_f32_16x16x32_bf16 v[60:63], v[76:79], a[100:103], v[60:63]
    ds_read_b64_tr_b16 v[104:105], v122 offset:49152
    ds_read_b64_tr_b16 v[106:107], v122 offset:51200
    v_mfma_f32_16x16x32_bf16 v[32:35], v[64:67], a[96:99], v[32:35]
    ds_read_b64_tr_b16 v[108:109], v123 offset:49152
    ds_read_b64_tr_b16 v[110:111], v123 offset:51200
    v_mfma_f32_16x16x32_bf16 v[36:39], v[68:71], a[96:99], v[36:39]
    s_add_u32 s62, s62, 2048
    v_mfma_f32_16x16x32_bf16 v[40:43], v[72:75], a[96:99], v[40:43]
    s_sub_u32 s59, s62, 43008
    v_mfma_f32_16x16x32_bf16 v[44:47], v[76:79], a[96:99], v[44:47]
    s_cselect_b32 s62, s62, s59
    s_waitcnt vmcnt(6) lgkmcnt(8)
    v_mfma_f32_16x16x32_bf16 v[48:51], v[80:83], a[108:111], v[48:51]
    v_cmp_gt_u32 vcc, 43, v24
    s_nop 0
    s_cbranch_vccnz L_cks_115
L_ck_116:
    v_mfma_f32_16x16x32_bf16 v[52:55], v[84:87], a[108:111], v[52:55]
    buffer_load_dwordx4 a[8:11], v126, s[12:15], s62 offen sc1
    buffer_load_dwordx4 a[12:15], v127, s[12:15], s62 offen sc1
    v_mfma_f32_16x16x32_bf16 v[56:59], v[88:91], a[108:111], v[56:59]
    ds_read_b64_tr_b16 v[64:65], v120 offset:57344
    ds_read_b64_tr_b16 v[66:67], v120 offset:59392
    v_mfma_f32_16x16x32_bf16 v[60:63], v[92:95], a[108:111], v[60:63]
    ds_read_b64_tr_b16 v[68:69], v121 offset:57344
    ds_read_b64_tr_b16 v[70:71], v121 offset:59392
    v_mfma_f32_16x16x32_bf16 v[32:35], v[80:83], a[104:107], v[32:35]
    ds_read_b64_tr_b16 v[72:73], v122 offset:57344
    ds_read_b64_tr_b16 v[74:75], v122 offset:59392
    v_mfma_f32_16x16x32_bf16 v[36:39], v[84:87], a[104:107], v[36:39]
    ds_read_b64_tr_b16 v[76:77], v123 offset:57344
    ds_read_b64_tr_b16 v[78:79], v123 offset:59392
    v_mfma_f32_16x16x32_bf16 v[40:43], v[88:91], a[104:107], v[40:43]
    s_add_u32 s62, s62, 2048
    s_sub_u32 s59, s62, 43008
    v_mfma_f32_16x16x32_bf16 v[44:47], v[92:95], a[104:107], v[44:47]
    s_cselect_b32 s62, s62, s59
    s_waitcnt vmcnt(6) lgkmcnt(8)
    v_mfma_f32_16x16x32_bf16 v[48:51], v[96:99], a[116:119], v[48:51]
    buffer_load_dwordx4 a[16:19], v126, s[12:15], s62 offen sc1
    buffer_load_dwordx4 a[20:23], v127, s[12:15], s62 offen sc1
    v_mfma_f32_16x16x32_bf16 v[52:55], v[100:103], a[116:119], v[52:55]
    ds_read_b32 v24, v4 offset:16
    v_add_u32 v120, 65536, v120
    v_mfma_f32_16x16x32_bf16 v[56:59], v[104:107], a[116:119], v[56:59]
    v_add_u32 v121, 65536, v121
    v_add_u32 v122, 65536, v122
    v_mfma_f32_16x16x32_bf16 v[60:63], v[108:111], a[116:119], v[60:63]
    v_add_u32 v123, 65536, v123
    ds_read_b64_tr_b16 v[80:81], v120 offset:0
    v_mfma_f32_16x16x32_bf16 v[32:35], v[96:99], a[112:115], v[32:35]
    ds_read_b64_tr_b16 v[82:83], v120 offset:2048
    ds_read_b64_tr_b16 v[84:85], v121 offset:0
    v_mfma_f32_16x16x32_bf16 v[36:39], v[100:103], a[112:115], v[36:39]
    ds_read_b64_tr_b16 v[86:87], v121 offset:2048
    ds_read_b64_tr_b16 v[88:89], v122 offset:0
    v_mfma_f32_16x16x32_bf16 v[40:43], v[104:107], a[112:115], v[40:43]
    ds_read_b64_tr_b16 v[90:91], v122 offset:2048
    ds_read_b64_tr_b16 v[92:93], v123 offset:0
    v_mfma_f32_16x16x32_bf16 v[44:47], v[108:111], a[112:115], v[44:47]
    ds_read_b64_tr_b16 v[94:95], v123 offset:2048
    s_add_u32 s62, s62, 2048
    s_sub_u32 s59, s62, 43008
    s_cselect_b32 s62, s62, s59
    s_waitcnt vmcnt(6) lgkmcnt(9)
    v_mfma_f32_16x16x32_bf16 v[48:51], v[64:67], a[124:127], v[48:51]
    buffer_load_dwordx4 a[24:27], v126, s[12:15], s62 offen sc1
    buffer_load_dwordx4 a[28:31], v127, s[12:15], s62 offen sc1
    v_mfma_f32_16x16x32_bf16 v[52:55], v[68:71], a[124:127], v[52:55]
    ds_read_b64_tr_b16 v[96:97], v120 offset:8192
    ds_read_b64_tr_b16 v[98:99], v120 offset:10240
    v_mfma_f32_16x16x32_bf16 v[56:59], v[72:75], a[124:127], v[56:59]
    ds_read_b64_tr_b16 v[100:101], v121 offset:8192
    ds_read_b64_tr_b16 v[102:103], v121 offset:10240
    v_mfma_f32_16x16x32_bf16 v[60:63], v[76:79], a[124:127], v[60:63]
    ds_read_b64_tr_b16 v[104:105], v122 offset:8192
    ds_read_b64_tr_b16 v[106:107], v122 offset:10240
    v_mfma_f32_16x16x32_bf16 v[32:35], v[64:67], a[120:123], v[32:35]
    ds_read_b64_tr_b16 v[108:109], v123 offset:8192
    ds_read_b64_tr_b16 v[110:111], v123 offset:10240
    v_mfma_f32_16x16x32_bf16 v[36:39], v[68:71], a[120:123], v[36:39]
    s_add_u32 s62, s62, 2048
    v_mfma_f32_16x16x32_bf16 v[40:43], v[72:75], a[120:123], v[40:43]
    s_sub_u32 s59, s62, 43008
    v_mfma_f32_16x16x32_bf16 v[44:47], v[76:79], a[120:123], v[44:47]
    s_cselect_b32 s62, s62, s59
    s_waitcnt vmcnt(6) lgkmcnt(8)
    v_mfma_f32_16x16x32_bf16 v[48:51], v[80:83], a[4:7], v[48:51]
    v_cmp_gt_u32 vcc, 45, v24
    s_nop 0
    s_cbranch_vccnz L_cks_119
L_ck_120:
    v_mfma_f32_16x16x32_bf16 v[52:55], v[84:87], a[4:7], v[52:55]
    buffer_load_dwordx4 a[32:35], v126, s[12:15], s62 offen sc1
    buffer_load_dwordx4 a[36:39], v127, s[12:15], s62 offen sc1
    v_mfma_f32_16x16x32_bf16 v[56:59], v[88:91], a[4:7], v[56:59]
    v_subrev_u32 v120, 131072, v120
    v_subrev_u32 v121, 131072, v121
    v_mfma_f32_16x16x32_bf16 v[60:63], v[92:95], a[4:7], v[60:63]
    v_subrev_u32 v122, 131072, v122
    v_subrev_u32 v123, 131072, v123
    v_mfma_f32_16x16x32_bf16 v[32:35], v[80:83], a[0:3], v[32:35]
    ds_read_b64_tr_b16 v[64:65], v120 offset:0
    ds_read_b64_tr_b16 v[66:67], v120 offset:2048
    v_mfma_f32_16x16x32_bf16 v[36:39], v[84:87], a[0:3], v[36:39]
    ds_read_b64_tr_b16 v[68:69], v121 offset:0
    ds_read_b64_tr_b16 v[70:71], v121 offset:2048
    v_mfma_f32_16x16x32_bf16 v[40:43], v[88:91], a[0:3], v[40:43]
    ds_read_b64_tr_b16 v[72:73], v122 offset:0
    ds_read_b64_tr_b16 v[74:75], v122 offset:2048
    v_mfma_f32_16x16x32_bf16 v[44:47], v[92:95], a[0:3], v[44:47]
    ds_read_b64_tr_b16 v[76:77], v123 offset:0
    ds_read_b64_tr_b16 v[78:79], v123 offset:2048
    s_mov_b32 s62, 43008
    s_waitcnt vmcnt(6) lgkmcnt(8)
    v_mfma_f32_16x16x32_bf16 v[48:51], v[96:99], a[12:15], v[48:51]
    buffer_load_dwordx4 a[40:43], v126, s[12:15], s62 offen sc1
    buffer_load_dwordx4 a[44:47], v127, s[12:15], s62 offen sc1
    v_mfma_f32_16x16x32_bf16 v[52:55], v[100:103], a[12:15], v[52:55]
    ds_read_b32 v24, v4 offset:16
    ds_read_b64_tr_b16 v[80:81], v120 offset:8192
    v_mfma_f32_16x16x32_bf16 v[56:59], v[104:107], a[12:15], v[56:59]
    ds_read_b64_tr_b16 v[82:83], v120 offset:10240
    ds_read_b64_tr_b16 v[84:85], v121 offset:8192
    v_mfma_f32_16x16x32_bf16 v[60:63], v[108:111], a[12:15], v[60:63]
    ds_read_b64_tr_b16 v[86:87], v121 offset:10240
    v_mfma_f32_16x16x32_bf16 v[32:35], v[96:99], a[8:11], v[32:35]
    ds_read_b64_tr_b16 v[88:89], v122 offset:8192
    v_mfma_f32_16x16x32_bf16 v[36:39], v[100:103], a[8:11], v[36:39]
    ds_read_b64_tr_b16 v[90:91], v122 offset:10240
    v_mfma_f32_16x16x32_bf16 v[40:43], v[104:107], a[8:11], v[40:43]
    ds_read_b64_tr_b16 v[92:93], v123 offset:8192
    v_mfma_f32_16x16x32_bf16 v[44:47], v[108:111], a[8:11], v[44:47]
    ds_read_b64_tr_b16 v[94:95], v123 offset:10240
    s_waitcnt vmcnt(6) lgkmcnt(9)
    v_mfma_f32_16x16x32_bf16 v[48:51], v[64:67], a[20:23], v[48:51]
    ds_read_b64_tr_b16 v[96:97], v120 offset:16384
    v_mfma_f32_16x16x32_bf16 v[52:55], v[68:71], a[20:23], v[52:55]
    ds_read_b64_tr_b16 v[98:99], v120 offset:18432
    v_mfma_f32_16x16x32_bf16 v[56:59], v[72:75], a[20:23], v[56:59]
    ds_read_b64_tr_b16 v[100:101], v121 offset:16384
    v_mfma_f32_16x16x32_bf16 v[60:63], v[76:79], a[20:23], v[60:63]
    ds_read_b64_tr_b16 v[102:103], v121 offset:18432
    v_mfma_f32_16x16x32_bf16 v[32:35], v[64:67], a[16:19], v[32:35]
    ds_read_b64_tr_b16 v[104:105], v122 offset:16384
    v_mfma_f32_16x16x32_bf16 v[36:39], v[68:71], a[16:19], v[36:39]
    ds_read_b64_tr_b16 v[106:107], v122 offset:18432
    v_mfma_f32_16x16x32_bf16 v[40:43], v[72:75], a[16:19], v[40:43]
    ds_read_b64_tr_b16 v[108:109], v123 offset:16384
    v_mfma_f32_16x16x32_bf16 v[44:47], v[76:79], a[16:19], v[44:47]
    ds_read_b64_tr_b16 v[110:111], v123 offset:18432
    s_waitcnt vmcnt(4) lgkmcnt(8)
    v_mfma_f32_16x16x32_bf16 v[48:51], v[80:83], a[28:31], v[48:51]
    v_cmp_gt_u32 vcc, 46, v24
    s_nop 0
    s_cbranch_vccnz L_cks_123
L_ck_124:
    v_mfma_f32_16x16x32_bf16 v[52:55], v[84:87], a[28:31], v[52:55]
    ds_read_b64_tr_b16 v[64:65], v120 offset:24576
    ds_read_b64_tr_b16 v[66:67], v120 offset:26624
    v_mfma_f32_16x16x32_bf16 v[56:59], v[88:91], a[28:31], v[56:59]
    ds_read_b64_tr_b16 v[68:69], v121 offset:24576
    v_mfma_f32_16x16x32_bf16 v[60:63], v[92:95], a[28:31], v[60:63]
    ds_read_b64_tr_b16 v[70:71], v121 offset:26624
    v_mfma_f32_16x16x32_bf16 v[32:35], v[80:83], a[24:27], v[32:35]
    ds_read_b64_tr_b16 v[72:73], v122 offset:24576
    v_mfma_f32_16x16x32_bf16 v[36:39], v[84:87], a[24:27], v[36:39]
    ds_read_b64_tr_b16 v[74:75], v122 offset:26624
    v_mfma_f32_16x16x32_bf16 v[40:43], v[88:91], a[24:27], v[40:43]
    ds_read_b64_tr_b16 v[76:77], v123 offset:24576
    v_mfma_f32_16x16x32_bf16 v[44:47], v[92:95], a[24:27], v[44:47]
    ds_read_b64_tr_b16 v[78:79], v123 offset:26624
    s_waitcnt vmcnt(2) lgkmcnt(8)
    v_mfma_f32_16x16x32_bf16 v[48:51], v[96:99], a[36:39], v[48:51]
    ds_read_b128 v[80:83], v115 offset:768
    v_mfma_f32_16x16x32_bf16 v[52:55], v[100:103], a[36:39], v[52:55]
    ds_read_b128 v[84:87], v115 offset:832
    v_mfma_f32_16x16x32_bf16 v[56:59], v[104:107], a[36:39], v[56:59]
    ds_read_b128 v[88:91], v115 offset:896
    v_mfma_f32_16x16x32_bf16 v[60:63], v[108:111], a[36:39], v[60:63]
    ds_read_b128 v[92:95], v115 offset:960
    v_mfma_f32_16x16x32_bf16 v[32:35], v[96:99], a[32:35], v[32:35]
    v_mfma_f32_16x16x32_bf16 v[36:39], v[100:103], a[32:35], v[36:39]
    v_mfma_f32_16x16x32_bf16 v[40:43], v[104:107], a[32:35], v[40:43]
    v_mfma_f32_16x16x32_bf16 v[44:47], v[108:111], a[32:35], v[44:47]
    s_cmp_lg_u32 s52, 0
    s_cbranch_scc1 L_p4_skip
    s_waitcnt vmcnt(0) lgkmcnt(4)
    v_mfma_f32_16x16x32_bf16 v[48:51], v[64:67], a[44:47], v[48:51]
    v_mfma_f32_16x16x32_bf16 v[52:55], v[68:71], a[44:47], v[52:55]
    v_mfma_f32_16x16x32_bf16 v[56:59], v[72:75], a[44:47], v[56:59]
    v_mfma_f32_16x16x32_bf16 v[60:63], v[76:79], a[44:47], v[60:63]
    v_mfma_f32_16x16x32_bf16 v[32:35], v[64:67], a[40:43], v[32:35]
    v_mfma_f32_16x16x32_bf16 v[36:39], v[68:71], a[40:43], v[36:39]
    v_mfma_f32_16x16x32_bf16 v[40:43], v[72:75], a[40:43], v[40:43]
    v_mfma_f32_16x16x32_bf16 v[44:47], v[76:79], a[40:43], v[44:47]
L_p4_skip:
    s_nop 0
    ds_write_b128 v26, v[48:51] offset:0
    ds_write_b128 v26, v[52:55] offset:1024
    ds_write_b128 v27, v[56:59] offset:0
    ds_write_b128 v27, v[60:63] offset:1024
    v_mov_b32 v24, 60
    ds_write_b32 v7, v24
    s_mov_b32 s63, 2097152
L_lw_127:
    ds_read_b32 v24, v29 offset:0
    ds_read_b128 v[96:99], v125 offset:0
    ds_read_b128 v[100:103], v125 offset:1024
    ds_read_b128 v[104:107], v28 offset:0
    ds_read_b128 v[108:111], v28 offset:1024
    s_sub_u32 s63, s63, 1
    s_cbranch_scc1 L_lwd_128
    s_waitcnt lgkmcnt(4)
    v_cmp_gt_u32 vcc, 60, v24
    s_nop 0
    s_cbranch_vccnz L_lw_127
L_lwd_128:
    s_waitcnt lgkmcnt(3)
    v_pk_add_f32 v[32:33], v[32:33], v[96:97]
    v_pk_add_f32 v[34:35], v[34:35], v[98:99]
    v_pk_fma_f32 v[8:9], v[32:33], v[80:81], v[8:9]
    v_pk_fma_f32 v[10:11], v[34:35], v[82:83], v[10:11]
    s_waitcnt lgkmcnt(2)
    v_pk_add_f32 v[36:37], v[36:37], v[100:101]
    v_pk_add_f32 v[38:39], v[38:39], v[102:103]
    v_pk_fma_f32 v[12:13], v[36:37], v[84:85], v[12:13]
    v_pk_fma_f32 v[14:15], v[38:39], v[86:87], v[14:15]
    s_waitcnt lgkmcnt(1)
    v_pk_add_f32 v[40:41], v[40:41], v[104:105]
    v_pk_add_f32 v[42:43], v[42:43], v[106:107]
    v_pk_fma_f32 v[16:17], v[40:41], v[88:89], v[16:17]
    v_pk_fma_f32 v[18:19], v[42:43], v[90:91], v[18:19]
    s_waitcnt lgkmcnt(0)
    v_pk_add_f32 v[44:45], v[44:45], v[108:109]
    v_pk_add_f32 v[46:47], v[46:47], v[110:111]
    v_pk_fma_f32 v[20:21], v[44:45], v[92:93], v[20:21]
    v_pk_fma_f32 v[22:23], v[46:47], v[94:95], v[22:23]
    v_cvt_pk_bf16_f32 v24, v8, v9
    v_cvt_pk_bf16_f32 v25, v10, v11
    ds_write_b64 v116, v[24:25]
    v_cvt_pk_bf16_f32 v26, v12, v13
    v_cvt_pk_bf16_f32 v27, v14, v15
    ds_write_b64 v117, v[26:27]
    v_cvt_pk_bf16_f32 v28, v16, v17
    v_cvt_pk_bf16_f32 v29, v18, v19
    ds_write_b64 v118, v[28:29]
    v_cvt_pk_bf16_f32 v30, v20, v21
    v_cvt_pk_bf16_f32 v31, v22, v23
    ds_write_b64 v119, v[30:31]
    ds_read_b128 v[32:35], v125
    ds_read_b128 v[36:39], v125 offset:1024
    s_waitcnt lgkmcnt(1)
    buffer_store_dwordx4 v[32:35], v112, s[44:47], s3 offen
    s_waitcnt lgkmcnt(0)
    buffer_store_dwordx4 v[36:39], v113, s[44:47], s3 offen
    s_branch L_fin
L_helper:
    s_mov_b32 s10, 0x180000
    s_mov_b32 s11, 0x20000
    s_mov_b32 s26, 0x4000
    s_mov_b32 s27, 0x20000
    v_lshrrev_b32 v12, 2, v0
    v_mul_u32_u24 v12, 3072, v12
    v_lshrrev_b32 v5, 4, v0
    v_and_b32 v5, 2, v5
    v_and_b32 v45, 3, v0
    v_xor_b32 v5, v5, v45
    v_lshl_add_u32 v45, v5, 4, v12
    s_lshl_b32 s69, s53, 10
    s_mul_i32 s75, s53, 49152
    s_lshl_b32 s59, s55, 6
    s_add_u32 s75, s75, s59
    s_add_u32 s75, s75, 1024
    s_lshr_b32 s61, s54, 1
    s_waitcnt lgkmcnt(0)
    s_barrier
    v_lshlrev_b32 v2, 7, v0
    s_cmp_eq_u32 s53, 1
    s_cbranch_scc1 L_h1
    s_cmp_eq_u32 s53, 2
    s_cbranch_scc1 L_h2
    s_cmp_eq_u32 s53, 3
    s_cbranch_scc1 L_h4
    s_branch L_h3
L_h1:
    s_getpc_b64 s[64:65]
L_pc:
    s_sub_u32 s64, s64, L_pc-adaLN_cond__linear_kernel_hedgehog__glu_gated_reglu__prompt_kernel
    s_subb_u32 s65, s65, 0
    s_lshr_b32 s59, s2, 3
    s_lshl_b32 s59, s59, 10
    v_add_u32 v3, s59, v2
    v_min_u32 v3, L_end-adaLN_cond__linear_kernel_hedgehog__glu_gated_reglu__prompt_kernel, v3
    s_mov_b64 exec, 0xff
    global_load_dword v10, v3, s[64:65]
    s_mov_b64 exec, -1
    s_branch L_h3
L_h2:
    s_lshl_b32 s59, s2, 8
    s_add_u32 s59, s59, 0x30000
    v_add_u32 v3, s59, v2
    s_lshl_b32 s59, s55, 7
    s_add_u32 s59, s59, s57
    s_add_u32 s59, s59, 0x80000
    v_writelane_b32 v3, s59, 2
    s_and_b32 s59, s2, 127
    s_lshl_b32 s59, s59, 7
    s_add_u32 s59, s59, 0x4000
    v_writelane_b32 v3, s59, 3
    s_waitcnt lgkmcnt(0)
    s_mov_b64 exec, 15
    buffer_load_dword v10, v3, s[12:15], 0 offen
    s_mov_b64 exec, -1
    s_branch L_h3
L_h4:
    s_mov_b32 m0, 106496
    s_lshl_b32 s59, s55, 10
    buffer_load_dwordx4 v1, s[24:27], s59 offen lds
L_h3:
    buffer_load_dword v127, v6, s[12:15], 0 offen sc1
    s_load_dwordx2 s[28:29], s[0:1], 24
    s_load_dwordx2 s[32:33], s[0:1], 40
    s_load_dwordx2 s[36:37], s[0:1], 48
    s_load_dwordx2 s[40:41], s[0:1], 56
    s_lshr_b32 s68, s2, 3
    s_lshl2_add_u32 s59, s68, s53
    s_mul_i32 s71, s59, 12288
    v_lshrrev_b32 v12, 4, v0
    v_mul_u32_u24 v12, 3072, v12
    v_and_b32 v13, 15, v0
    v_lshl_add_u32 v44, v13, 7, v12
    s_mov_b32 exec_lo, 0x08080808
    s_mov_b32 exec_hi, 0x08080808
    buffer_load_dword v10, v44, s[8:11], s71 offen offset:1024
    s_mov_b32 exec_lo, 0x00080008
    s_mov_b32 exec_hi, 0x00080008
    buffer_load_dword v10, v44, s[8:11], s71 offen
    s_mov_b64 exec, -1
    s_cmp_ge_u32 s49, 32
    s_cbranch_scc1 L_nohold
    s_waitcnt lgkmcnt(0)
    s_mov_b32 s63, 2097152
L_lw_129:
    ds_read_b32 v12, v4 offset:0
    s_sub_u32 s63, s63, 1
    s_cbranch_scc1 L_lwd_130
    s_waitcnt lgkmcnt(0)
    v_cmp_gt_u32 vcc, 1, v12
    s_nop 0
    s_cbranch_vccz L_lwd_130
    s_sleep 2
    s_branch L_lw_129
L_lwd_130:
L_nohold:
    s_cmp_ge_u32 s49, 32
    s_cselect_b32 s63, 7, 3
    s_sub_u32 s62, 8, s63
L_wd_131:
    s_sub_u32 s63, s63, 1
    s_cbranch_scc1 L_wdd_132
    s_mul_i32 s59, s61, 196608
    s_lshl_b32 s60, s61, 12
    s_add_u32 s59, s59, s75
    s_add_u32 s60, s60, s69
    s_add_u32 s61, s61, 1
    s_add_u32 m0, s60, 0
    s_and_b32 s61, s61, 7
    buffer_load_dwordx4 v45, s[8:11], s59 offen offset:0 lds
    s_add_u32 m0, s60, 31744
    s_and_b32 s61, s61, 7
    buffer_load_dwordx4 v45, s[8:11], s59 offen offset:1024 lds
    s_branch L_wd_131
L_wdd_132:
    v_mov_b32 v12, 1
    ds_write_b32 v7, v12
    s_mov_b32 s63, s62
L_wd_133:
    s_sub_u32 s63, s63, 1
    s_cbranch_scc1 L_wdd_134
    s_mul_i32 s59, s61, 196608
    s_lshl_b32 s60, s61, 12
    s_add_u32 s59, s59, s75
    s_add_u32 s60, s60, s69
    s_add_u32 s61, s61, 1
    s_add_u32 m0, s60, 0
    s_and_b32 s61, s61, 7
    buffer_load_dwordx4 v45, s[8:11], s59 offen offset:0 lds
    s_add_u32 m0, s60, 31744
    s_and_b32 s61, s61, 7
    buffer_load_dwordx4 v45, s[8:11], s59 offen offset:1024 lds
    s_branch L_wd_133
L_wdd_134:
    s_cmp_ge_u32 s53, 2
    s_cbranch_scc1 L_pw
    v_add_u32 v46, 98304, v45
    s_mov_b32 s30, 0x80000
    s_mov_b32 s31, 0x20000
    s_mov_b32 s34, 0x158000
    s_mov_b32 s35, 0x20000
    s_mov_b32 s38, 0x158000
    s_mov_b32 s39, 0x20000
    s_mov_b32 s42, 0x158000
    s_mov_b32 s43, 0x20000
    v_add_u32 v12, 0, v0
    v_mul_u32_u24 v13, 0x5556, v12
    v_lshrrev_b32 v13, 18, v13
    v_lshrrev_b32 v14, 1, v13
    v_and_b32 v14, 2, v14
    v_xor_b32 v12, v12, v14
    v_mul_u32_u24 v13, 2560, v13
    v_lshl_add_u32 v48, v12, 4, v13
    v_add_u32 v12, 64, v0
    v_mul_u32_u24 v13, 0x5556, v12
    v_lshrrev_b32 v13, 18, v13
    v_lshrrev_b32 v14, 1, v13
    v_and_b32 v14, 2, v14
    v_xor_b32 v12, v12, v14
    v_mul_u32_u24 v13, 2560, v13
    v_lshl_add_u32 v49, v12, 4, v13
    v_add_u32 v12, 128, v0
    v_mul_u32_u24 v13, 0x5556, v12
    v_lshrrev_b32 v13, 18, v13
    v_lshrrev_b32 v14, 1, v13
    v_and_b32 v14, 2, v14
    v_xor_b32 v12, v12, v14
    v_mul_u32_u24 v13, 2560, v13
    v_lshl_add_u32 v50, v12, 4, v13
    s_mul_i32 s66, s55, 192
    s_mul_i32 s67, s53, 6144
    v_lshlrev_b32 v51, 10, v8
    v_and_b32 v13, 6, v8
    v_xor_b32 v13, v13, v9
    v_lshl_add_u32 v51, v13, 4, v51
    s_and_b32 s62, s55, 7
    s_lshl_b32 s60, s62, 7
    s_lshl_b32 s59, s53, 13
    s_add_u32 s59, s59, s60
    v_add_u32 v51, s59, v51
    v_add_u32 v47, 16384, v51
    v_and_b32 v14, 48, v0
    v_lshl_add_u32 v52, v9, 6, v14
    v_lshrrev_b32 v54, 5, v0
    v_lshl_add_u32 v54, v54, 5, s68
    v_mul_u32_u24 v54, 2752, v54
    v_and_b32 v13, 31, v0
    v_lshlrev_b32 v13, 7, v13
    v_min_u32 v13, 2748, v13
    v_add_u32 v54, v54, v13
    v_lshl_add_u32 v56, v8, 5, s68
    v_lshlrev_b32 v56, 10, v56
    v_lshl_add_u32 v56, v9, 7, v56
    s_lshl3_add_u32 s74, s53, s62
    s_lshl_b32 s74, s74, 12
    s_add_u32 s74, s74, 0x10000
    v_lshlrev_b32 v58, 3, v0
    s_lshl_b32 s59, s53, 8
    s_add_u32 s59, s59, 162816
    v_lshl_add_u32 v59, v0, 2, s59
    s_lshl_b32 s59, s53, 8
    s_add_u32 s59, s59, s55
    s_lshl_b32 s59, s59, 10
    s_add_u32 s59, s59, 0x8000
    v_and_b32 v53, 1, v8
    v_lshlrev_b32 v53, 14, v53
    v_lshrrev_b32 v13, 4, v0
    v_lshl_add_u32 v53, v13, 17, v53
    v_lshl_add_u32 v53, v9, 7, v53
    v_add_u32 v53, s59, v53
    s_lshl1_add_u32 s59, s55, s53
    s_lshl_b32 s59, s59, 9
    s_add_u32 s59, s59, 0x81000
    v_lshl_add_u32 v55, v9, 7, s59
    v_cmp_gt_u32 vcc, 32, v0
    s_nop 1
    v_cndmask_b32 v53, v55, v53, vcc
    s_lshl_b32 s59, s53, 17
    s_mul_i32 s60, s55, 6144
    s_add_u32 s59, s59, s60
    s_add_u32 s59, s59, 0x8000
    v_add_u32 v57, s59, v2
    s_and_b32 s54, s54, 14
    s_cmp_eq_u32 s54, 14
    s_cselect_b32 s65, 0, s54
    s_mov_b32 s72, s54
    s_lshl2_add_u32 s77, s53, s65
    s_mov_b32 s76, s54
    s_mul_i32 s70, s65, 98304
    s_mov_b32 s73, 98304
    s_waitcnt lgkmcnt(0)
    s_bitcmp1_b32 s53, 0
    s_cselect_b64 s[48:49], s[36:37], s[32:33]
    s_mov_b32 s50, 1409024
    s_mov_b32 s51, 0x20000
    s_sub_u32 s75, s75, 1024
    s_waitcnt vmcnt(0)
    v_mov_b32 v12, 2
    ds_write_b32 v7, v12
    v_add_u32 v127, 1, v127
    s_nop 0
    v_readfirstlane_b32 s56, v127
    s_mov_b32 s63, 2097152
L_lw_135:
    ds_read_b32 v15, v4 offset:0
    s_sub_u32 s63, s63, 1
    s_cbranch_scc1 L_lwd_136
    s_waitcnt lgkmcnt(0)
    v_cmp_gt_u32 vcc, 3, v15
    s_nop 0
    s_cbranch_vccz L_lwd_136
    s_sleep 2
    s_branch L_lw_135
L_lwd_136:
    s_cmp_lg_u32 s53, 0
    s_cbranch_scc1 L_li
    s_and_b32 s59, s2, 7
    v_and_b32 v13, 3, v0
    v_lshlrev_b32 v13, 2, v13
    v_lshl_add_u32 v13, v8, 4, v13
    s_lshl_b32 s60, s59, 7
    buffer_load_dword v12, v13, s[20:23], s60 offen
    v_mul_u32_u24 v14, 49152, v8
    v_lshl_add_u32 v14, v9, 4, v14
    s_mul_i32 s59, s59, 393216
    s_lshr_b32 s60, s2, 3
    s_add_u32 s60, s60, 16
    s_lshl_b32 s60, s60, 7
    s_add_u32 s59, s59, s60
    buffer_load_dwordx4 v[64:67], v14, s[16:19], s59 offen
    s_add_u32 s59, s59, 6144
    buffer_load_dwordx4 v[68:71], v14, s[16:19], s59 offen
    s_add_u32 s59, s59, 6144
    buffer_load_dwordx4 v[72:75], v14, s[16:19], s59 offen
    s_add_u32 s59, s59, 6144
    buffer_load_dwordx4 v[76:79], v14, s[16:19], s59 offen
    s_add_u32 s59, s59, 6144
    buffer_load_dwordx4 v[80:83], v14, s[16:19], s59 offen
    s_add_u32 s59, s59, 6144
    buffer_load_dwordx4 v[84:87], v14, s[16:19], s59 offen
    s_add_u32 s59, s59, 6144
    buffer_load_dwordx4 v[88:91], v14, s[16:19], s59 offen
    s_add_u32 s59, s59, 6144
    buffer_load_dwordx4 v[92:95], v14, s[16:19], s59 offen
L_li:
    s_mov_b32 s63, 8
L_wd_137:
    s_sub_u32 s63, s63, 1
    s_cbranch_scc1 L_wdd_138
    s_mul_i32 s59, s61, 196608
    s_lshl_b32 s60, s61, 12
    s_add_u32 s59, s59, s75
    s_add_u32 s60, s60, s69
    s_add_u32 s61, s61, 1
    s_add_u32 m0, s60, 65536
    s_and_b32 s61, s61, 7
    buffer_load_dwordx4 v45, s[8:11], s59 offen offset:0 lds
    s_add_u32 m0, s60, 67584
    s_and_b32 s61, s61, 7
    buffer_load_dwordx4 v46, s[8:11], s59 offen offset:0 lds
    s_branch L_wd_137
L_wdd_138:
    s_waitcnt vmcnt(0)
    v_mov_b32 v15, 3
    ds_write_b32 v7, v15
    s_mov_b32 s63, 2097152
L_lw_139:
    ds_read_b32 v15, v4 offset:0
    s_sub_u32 s63, s63, 1
    s_cbranch_scc1 L_lwd_140
    s_waitcnt lgkmcnt(0)
    v_cmp_gt_u32 vcc, 4, v15
    s_nop 0
    s_cbranch_vccz L_lwd_140
    s_sleep 2
    s_branch L_lw_139
L_lwd_140:
    s_mov_b32 s63, 16
L_wo:
    s_lshl_b32 s60, s76, 12
    s_lshl_b32 s59, s76, 15
    s_add_u32 m0, s60, s69
    s_add_u32 s76, s76, 1
    buffer_load_dwordx4 v51, s[28:31], s59 offen lds
    s_add_u32 m0, m0, 2048
    s_and_b32 s76, s76, 15
    buffer_load_dwordx4 v47, s[28:31], s59 offen lds
    s_sub_u32 s63, s63, 1
    s_cmp_lg_u32 s63, 0
    s_cbranch_scc1 L_wo
    s_cmp_lg_u32 s53, 0
    s_cbranch_scc1 L_lc
    s_waitcnt vmcnt(48)
    v_lshlrev_b32 v13, 16, v12
    v_and_b32 v14, v126, v12
    v_mul_f32 v15, 0xbfb8aa3b, v13
    v_mul_f32 v16, 0xbfb8aa3b, v14
    v_exp_f32 v15, v15
    v_exp_f32 v16, v16
    s_mov_b32 s59, 0x05040100
    s_mov_b32 s60, 0x07060302
    v_add_f32 v15, 1.0, v15
    v_add_f32 v16, 1.0, v16
    v_rcp_f32 v15, v15
    v_rcp_f32 v16, v16
    v_mov_b32 v24, 0
    v_mov_b32 v25, 0
    v_mov_b32 v26, 0
    v_mov_b32 v27, 0
    v_mov_b32 v28, 0
    v_mov_b32 v29, 0
    v_mov_b32 v30, 0
    v_mov_b32 v31, 0
    v_mul_f32 v13, v13, v15
    v_mul_f32 v14, v14, v16
    v_cvt_pk_bf16_f32 v12, v13, v14
    s_nop 1
    v_mov_b32_dpp v16, v12 quad_perm:[0,0,0,0] row_mask:0xf bank_mask:0xf
    v_mov_b32_dpp v17, v12 quad_perm:[1,1,1,1] row_mask:0xf bank_mask:0xf
    v_mov_b32_dpp v18, v12 quad_perm:[2,2,2,2] row_mask:0xf bank_mask:0xf
    v_mov_b32_dpp v19, v12 quad_perm:[3,3,3,3] row_mask:0xf bank_mask:0xf
    v_perm_b32 v20, v68, v64, s59
    v_perm_b32 v21, v68, v64, s60
    v_perm_b32 v22, v69, v65, s59
    v_perm_b32 v23, v69, v65, s60
    v_dot2c_f32_bf16 v24, v20, v16
    v_dot2c_f32_bf16 v25, v21, v16
    v_dot2c_f32_bf16 v26, v22, v16
    v_dot2c_f32_bf16 v27, v23, v16
    v_perm_b32 v20, v70, v66, s59
    v_perm_b32 v21, v70, v66, s60
    v_perm_b32 v22, v71, v67, s59
    v_perm_b32 v23, v71, v67, s60
    v_dot2c_f32_bf16 v28, v20, v16
    v_dot2c_f32_bf16 v29, v21, v16
    v_dot2c_f32_bf16 v30, v22, v16
    v_dot2c_f32_bf16 v31, v23, v16
    v_perm_b32 v20, v76, v72, s59
    v_perm_b32 v21, v76, v72, s60
    v_perm_b32 v22, v77, v73, s59
    v_perm_b32 v23, v77, v73, s60
    v_dot2c_f32_bf16 v24, v20, v17
    v_dot2c_f32_bf16 v25, v21, v17
    v_dot2c_f32_bf16 v26, v22, v17
    v_dot2c_f32_bf16 v27, v23, v17
    v_perm_b32 v20, v78, v74, s59
    v_perm_b32 v21, v78, v74, s60
    v_perm_b32 v22, v79, v75, s59
    v_perm_b32 v23, v79, v75, s60
    v_dot2c_f32_bf16 v28, v20, v17
    v_dot2c_f32_bf16 v29, v21, v17
    v_dot2c_f32_bf16 v30, v22, v17
    v_dot2c_f32_bf16 v31, v23, v17
    v_perm_b32 v20, v84, v80, s59
    v_perm_b32 v21, v84, v80, s60
    v_perm_b32 v22, v85, v81, s59
    v_perm_b32 v23, v85, v81, s60
    v_dot2c_f32_bf16 v24, v20, v18
    v_dot2c_f32_bf16 v25, v21, v18
    v_dot2c_f32_bf16 v26, v22, v18
    v_dot2c_f32_bf16 v27, v23, v18
    v_perm_b32 v20, v86, v82, s59
    v_perm_b32 v21, v86, v82, s60
    v_perm_b32 v22, v87, v83, s59
    v_perm_b32 v23, v87, v83, s60
    v_dot2c_f32_bf16 v28, v20, v18
    v_dot2c_f32_bf16 v29, v21, v18
    v_dot2c_f32_bf16 v30, v22, v18
    v_dot2c_f32_bf16 v31, v23, v18
    v_perm_b32 v20, v92, v88, s59
    v_perm_b32 v21, v92, v88, s60
    v_perm_b32 v22, v93, v89, s59
    v_perm_b32 v23, v93, v89, s60
    v_dot2c_f32_bf16 v24, v20, v19
    v_dot2c_f32_bf16 v25, v21, v19
    v_dot2c_f32_bf16 v26, v22, v19
    v_dot2c_f32_bf16 v27, v23, v19
    v_perm_b32 v20, v94, v90, s59
    v_perm_b32 v21, v94, v90, s60
    v_perm_b32 v22, v95, v91, s59
    v_perm_b32 v23, v95, v91, s60
    v_dot2c_f32_bf16 v28, v20, v19
    v_dot2c_f32_bf16 v29, v21, v19
    v_dot2c_f32_bf16 v30, v22, v19
    v_dot2c_f32_bf16 v31, v23, v19
    v_permlane32_swap_b32 v24, v28
    v_permlane32_swap_b32 v25, v29
    v_permlane32_swap_b32 v26, v30
    v_permlane32_swap_b32 v27, v31
    v_pk_add_f32 v[24:25], v[24:25], v[28:29]
    v_pk_add_f32 v[26:27], v[26:27], v[30:31]
    s_nop 1
    v_permlane16_swap_b32 v24, v26
    v_permlane16_swap_b32 v25, v27
    v_pk_add_f32 v[24:25], v[24:25], v[26:27]
    s_nop 1
    v_add_f32_dpp v26, v24, v24 row_ror:8 row_mask:0xf bank_mask:0xf
    v_add_f32_dpp v27, v25, v25 row_ror:8 row_mask:0xf bank_mask:0xf
    s_lshl_b32 s59, s2, 9
    s_add_u32 s59, s59, 0x10000
    v_mov_b32 v28, v27
    v_mov_b32 v27, v127
    v_mov_b32 v29, v127
    buffer_store_dwordx4 v[26:29], v52, s[12:15], s59 offen sc1
L_lc:
    s_mov_b32 s63, 2097152
L_lw_141:
    ds_read_b32 v15, v4 offset:0
    s_sub_u32 s63, s63, 1
    s_cbranch_scc1 L_lwd_142
    s_waitcnt lgkmcnt(0)
    v_cmp_gt_u32 vcc, 6, v15
    s_nop 0
    s_cbranch_vccz L_lwd_142
    s_sleep 2
    s_branch L_lw_141
L_lwd_142:
    s_mul_i32 s59, s54, 88064
    s_add_u32 s60, s73, s67
    s_add_u32 s59, s59, s66
    s_add_u32 m0, s60, 0
    s_add_u32 s54, s54, 1
    buffer_load_dwordx4 v48, s[48:51], s59 offen lds
    s_add_u32 m0, s60, 1024
    s_and_b32 s54, s54, 15
    buffer_load_dwordx4 v49, s[48:51], s59 offen lds
    s_add_u32 m0, s60, 2048
    s_add_u32 s73, s73, 12288
    buffer_load_dwordx4 v50, s[48:51], s59 offen lds
    s_add_u32 m0, s60, 3072
    s_add_u32 s59, s59, 44032
    buffer_load_dwordx4 v48, s[48:51], s59 offen lds
    s_add_u32 m0, s60, 4096
    s_nop 0
    buffer_load_dwordx4 v49, s[48:51], s59 offen lds
    s_add_u32 m0, s60, 5120
    s_nop 0
    buffer_load_dwordx4 v50, s[48:51], s59 offen lds
    s_cmp_lg_u32 s73, 147456
    s_cselect_b32 s73, s73, 0
    s_mul_i32 s59, s54, 88064
    s_add_u32 s60, s73, s67
    s_add_u32 s59, s59, s66
    s_add_u32 m0, s60, 0
    s_add_u32 s54, s54, 1
    buffer_load_dwordx4 v48, s[48:51], s59 offen lds
    s_add_u32 m0, s60, 1024
    s_and_b32 s54, s54, 15
    buffer_load_dwordx4 v49, s[48:51], s59 offen lds
    s_add_u32 m0, s60, 2048
    s_add_u32 s73, s73, 12288
    buffer_load_dwordx4 v50, s[48:51], s59 offen lds
    s_add_u32 m0, s60, 3072
    s_add_u32 s59, s59, 44032
    buffer_load_dwordx4 v48, s[48:51], s59 offen lds
    s_add_u32 m0, s60, 4096
    s_nop 0
    buffer_load_dwordx4 v49, s[48:51], s59 offen lds
    s_add_u32 m0, s60, 5120
    s_nop 0
    buffer_load_dwordx4 v50, s[48:51], s59 offen lds
    s_cmp_lg_u32 s73, 147456
    s_cselect_b32 s73, s73, 0
    s_mov_b32 s63, 2097152
L_lw_143:
    ds_read_b32 v15, v4 offset:0
    s_sub_u32 s63, s63, 1
    s_cbranch_scc1 L_lwd_144
    s_waitcnt lgkmcnt(0)
    v_cmp_gt_u32 vcc, 7, v15
    s_nop 0
    s_cbranch_vccz L_lwd_144
    s_sleep 2
    s_branch L_lw_143
L_lwd_144:
    s_mul_i32 s59, s54, 88064
    s_add_u32 s60, s73, s67
    s_add_u32 s59, s59, s66
    s_add_u32 m0, s60, 0
    s_add_u32 s54, s54, 1
    buffer_load_dwordx4 v48, s[48:51], s59 offen lds
    s_add_u32 m0, s60, 1024
    s_and_b32 s54, s54, 15
    buffer_load_dwordx4 v49, s[48:51], s59 offen lds
    s_add_u32 m0, s60, 2048
    s_add_u32 s73, s73, 12288
    buffer_load_dwordx4 v50, s[48:51], s59 offen lds
    s_add_u32 m0, s60, 3072
    s_add_u32 s59, s59, 44032
    buffer_load_dwordx4 v48, s[48:51], s59 offen lds
    s_add_u32 m0, s60, 4096
    s_nop 0
    buffer_load_dwordx4 v49, s[48:51], s59 offen lds
    s_add_u32 m0, s60, 5120
    s_nop 0
    buffer_load_dwordx4 v50, s[48:51], s59 offen lds
    s_cmp_lg_u32 s73, 147456
    s_cselect_b32 s73, s73, 0
    s_mul_i32 s59, s54, 88064
    s_add_u32 s60, s73, s67
    s_add_u32 s59, s59, s66
    s_add_u32 m0, s60, 0
    s_add_u32 s54, s54, 1
    buffer_load_dwordx4 v48, s[48:51], s59 offen lds
    s_add_u32 m0, s60, 1024
    s_and_b32 s54, s54, 15
    buffer_load_dwordx4 v49, s[48:51], s59 offen lds
    s_add_u32 m0, s60, 2048
    s_add_u32 s73, s73, 12288
    buffer_load_dwordx4 v50, s[48:51], s59 offen lds
    s_add_u32 m0, s60, 3072
    s_add_u32 s59, s59, 44032
    buffer_load_dwordx4 v48, s[48:51], s59 offen lds
    s_add_u32 m0, s60, 4096
    s_nop 0
    buffer_load_dwordx4 v49, s[48:51], s59 offen lds
    s_add_u32 m0, s60, 5120
    s_nop 0
    buffer_load_dwordx4 v50, s[48:51], s59 offen lds
    s_cmp_lg_u32 s73, 147456
    s_cselect_b32 s73, s73, 0
    v_mov_b32 v14, 19
    s_waitcnt vmcnt(0)
    ds_write_b32 v7, v14
    s_mov_b32 s63, 262144
    s_branch L_gat1
L_gat:
    s_sleep 8
L_gat1:
    s_add_u32 s59, s74, 65536
    buffer_load_dwordx2 v[64:65], v58, s[12:15], s74 offen offset:0 sc1
    buffer_load_dwordx2 v[66:67], v58, s[12:15], s74 offen offset:512 sc1
    buffer_load_dwordx2 v[68:69], v58, s[12:15], s74 offen offset:1024 sc1
    buffer_load_dwordx2 v[70:71], v58, s[12:15], s74 offen offset:1536 sc1
    buffer_load_dwordx2 v[72:73], v58, s[12:15], s74 offen offset:2048 sc1
    buffer_load_dwordx2 v[74:75], v58, s[12:15], s74 offen offset:2560 sc1
    buffer_load_dwordx2 v[76:77], v58, s[12:15], s74 offen offset:3072 sc1
    buffer_load_dwordx2 v[78:79], v58, s[12:15], s74 offen offset:3584 sc1
    buffer_load_dwordx2 v[80:81], v58, s[12:15], s59 offen offset:0 sc1
    buffer_load_dwordx2 v[82:83], v58, s[12:15], s59 offen offset:512 sc1
    buffer_load_dwordx2 v[84:85], v58, s[12:15], s59 offen offset:1024 sc1
    buffer_load_dwordx2 v[86:87], v58, s[12:15], s59 offen offset:1536 sc1
    buffer_load_dwordx2 v[88:89], v58, s[12:15], s59 offen offset:2048 sc1
    buffer_load_dwordx2 v[90:91], v58, s[12:15], s59 offen offset:2560 sc1
    buffer_load_dwordx2 v[92:93], v58, s[12:15], s59 offen offset:3072 sc1
    buffer_load_dwordx2 v[94:95], v58, s[12:15], s59 offen offset:3584 sc1
    v_mov_b32 v21, 0
    s_waitcnt vmcnt(0)
    v_bitop3_b32 v21, v21, v65, v127 bitop3:0xf6
    v_bitop3_b32 v21, v21, v81, v127 bitop3:0xf6
    v_bitop3_b32 v21, v21, v67, v127 bitop3:0xf6
    v_add_f32 v64, v64, v66
    v_bitop3_b32 v21, v21, v83, v127 bitop3:0xf6
    v_add_f32 v80, v80, v82
    v_bitop3_b32 v21, v21, v69, v127 bitop3:0xf6
    v_add_f32 v64, v64, v68
    v_bitop3_b32 v21, v21, v85, v127 bitop3:0xf6
    v_add_f32 v80, v80, v84
    v_bitop3_b32 v21, v21, v71, v127 bitop3:0xf6
    v_add_f32 v64, v64, v70
    v_bitop3_b32 v21, v21, v87, v127 bitop3:0xf6
    v_add_f32 v80, v80, v86
    v_bitop3_b32 v21, v21, v73, v127 bitop3:0xf6
    v_add_f32 v64, v64, v72
    v_bitop3_b32 v21, v21, v89, v127 bitop3:0xf6
    v_add_f32 v80, v80, v88
    v_bitop3_b32 v21, v21, v75, v127 bitop3:0xf6
    v_add_f32 v64, v64, v74
    v_bitop3_b32 v21, v21, v91, v127 bitop3:0xf6
    v_add_f32 v80, v80, v90
    v_bitop3_b32 v21, v21, v77, v127 bitop3:0xf6
    v_add_f32 v64, v64, v76
    v_bitop3_b32 v21, v21, v93, v127 bitop3:0xf6
    v_add_f32 v80, v80, v92
    v_bitop3_b32 v21, v21, v79, v127 bitop3:0xf6
    v_add_f32 v64, v64, v78
    v_bitop3_b32 v21, v21, v95, v127 bitop3:0xf6
    v_add_f32 v80, v80, v94
    s_sub_u32 s63, s63, 1
    s_cbranch_scc1 L_gatd
    v_cmp_ne_u32 vcc, 0, v21
    s_nop 0
    s_cbranch_vccnz L_gat
L_gatd:
    s_cmp_eq_u32 s53, 0
    s_cselect_b32 s59, 1.0, 0
    v_cvt_pk_bf16_f32 v24, v64, v80
    v_and_b32 v25, v126, v24
    v_lshlrev_b32 v24, 16, v24
    v_add_f32 v25, s59, v25
    v_cvt_pk_bf16_f32 v25, v25, v25
    v_and_b32 v25, v126, v25
    ds_write2st64_b32 v59, v24, v25 offset0:0 offset1:2
    v_mov_b32 v15, 1
    ds_write_b32 v7, v15 offset:32
    s_mov_b32 s63, 2097152
L_lw_145:
    ds_read_b32 v15, v4 offset:0
    s_sub_u32 s63, s63, 1
    s_cbranch_scc1 L_lwd_146
    s_waitcnt lgkmcnt(0)
    v_cmp_gt_u32 vcc, 10, v15
    s_nop 0
    s_cbranch_vccz L_lwd_146
    s_sleep 2
    s_branch L_lw_145
L_lwd_146:
    s_mul_i32 s59, s54, 88064
    s_add_u32 s60, s73, s67
    s_add_u32 s59, s59, s66
    s_add_u32 m0, s60, 0
    s_add_u32 s54, s54, 1
    buffer_load_dwordx4 v48, s[48:51], s59 offen lds
    s_add_u32 m0, s60, 1024
    s_and_b32 s54, s54, 15
    buffer_load_dwordx4 v49, s[48:51], s59 offen lds
    s_add_u32 m0, s60, 2048
    s_add_u32 s73, s73, 12288
    buffer_load_dwordx4 v50, s[48:51], s59 offen lds
    s_add_u32 m0, s60, 3072
    s_add_u32 s59, s59, 44032
    buffer_load_dwordx4 v48, s[48:51], s59 offen lds
    s_add_u32 m0, s60, 4096
    s_nop 0
    buffer_load_dwordx4 v49, s[48:51], s59 offen lds
    s_add_u32 m0, s60, 5120
    s_nop 0
    buffer_load_dwordx4 v50, s[48:51], s59 offen lds
    s_cmp_lg_u32 s73, 147456
    s_cselect_b32 s73, s73, 0
    s_mul_i32 s59, s54, 88064
    s_add_u32 s60, s73, s67
    s_add_u32 s59, s59, s66
    s_add_u32 m0, s60, 0
    s_add_u32 s54, s54, 1
    buffer_load_dwordx4 v48, s[48:51], s59 offen lds
    s_add_u32 m0, s60, 1024
    s_and_b32 s54, s54, 15
    buffer_load_dwordx4 v49, s[48:51], s59 offen lds
    s_add_u32 m0, s60, 2048
    s_add_u32 s73, s73, 12288
    buffer_load_dwordx4 v50, s[48:51], s59 offen lds
    s_add_u32 m0, s60, 3072
    s_add_u32 s59, s59, 44032
    buffer_load_dwordx4 v48, s[48:51], s59 offen lds
    s_add_u32 m0, s60, 4096
    s_nop 0
    buffer_load_dwordx4 v49, s[48:51], s59 offen lds
    s_add_u32 m0, s60, 5120
    s_nop 0
    buffer_load_dwordx4 v50, s[48:51], s59 offen lds
    s_cmp_lg_u32 s73, 147456
    s_cselect_b32 s73, s73, 0
    s_mul_i32 s59, s54, 88064
    s_add_u32 s60, s73, s67
    s_add_u32 s59, s59, s66
    s_add_u32 m0, s60, 0
    s_add_u32 s54, s54, 1
    buffer_load_dwordx4 v48, s[48:51], s59 offen lds
    s_add_u32 m0, s60, 1024
    s_and_b32 s54, s54, 15
    buffer_load_dwordx4 v49, s[48:51], s59 offen lds
    s_add_u32 m0, s60, 2048
    s_add_u32 s73, s73, 12288
    buffer_load_dwordx4 v50, s[48:51], s59 offen lds
    s_add_u32 m0, s60, 3072
    s_add_u32 s59, s59, 44032
    buffer_load_dwordx4 v48, s[48:51], s59 offen lds
    s_add_u32 m0, s60, 4096
    s_nop 0
    buffer_load_dwordx4 v49, s[48:51], s59 offen lds
    s_add_u32 m0, s60, 5120
    s_nop 0
    buffer_load_dwordx4 v50, s[48:51], s59 offen lds
    s_cmp_lg_u32 s73, 147456
    s_cselect_b32 s73, s73, 0
    v_mov_b32 v14, 22
    s_waitcnt vmcnt(0)
    ds_write_b32 v7, v14
    s_mov_b32 s63, 2097152
L_lw_147:
    ds_read_b32 v15, v4 offset:0
    s_sub_u32 s63, s63, 1
    s_cbranch_scc1 L_lwd_148
    s_waitcnt lgkmcnt(0)
    v_cmp_gt_u32 vcc, 15, v15
    s_nop 0
    s_cbranch_vccz L_lwd_148
    s_sleep 2
    s_branch L_lw_147
L_lwd_148:
    s_cmp_lg_u32 s2, 0
    s_cbranch_scc1 L_ep_skip
    buffer_store_dword v127, v6, s[12:15], 0 offen sc1
L_ep_skip:
    s_mov_b32 s74, 11
    v_subrev_u32 v13, 1, v14
    s_cmp_lg_u32 s55, 15
    s_cbranch_scc1 L_ring_gu
    s_mov_b32 s74, 20
    s_mov_b32 s73, 0
    v_mov_b32 v13, 30
    s_branch L_ring_w0
L_ring_gu:
    s_mov_b32 s63, 2097152
L_lw_149:
    ds_read_b32 v12, v4 offset:0
    s_sub_u32 s63, s63, 1
    s_cbranch_scc1 L_lwd_150
    s_waitcnt lgkmcnt(0)
    v_cmp_gt_u32 vcc, s74, v12
    s_nop 0
    s_cbranch_vccz L_lwd_150
    s_sleep 2
    s_branch L_lw_149
L_lwd_150:
    s_mul_i32 s59, s54, 88064
    s_add_u32 s60, s73, s67
    s_add_u32 s59, s59, s66
    s_add_u32 m0, s60, 0
    s_add_u32 s54, s54, 1
    buffer_load_dwordx4 v48, s[48:51], s59 offen lds
    s_add_u32 m0, s60, 1024
    s_and_b32 s54, s54, 15
    buffer_load_dwordx4 v49, s[48:51], s59 offen lds
    s_add_u32 m0, s60, 2048
    s_add_u32 s73, s73, 12288
    buffer_load_dwordx4 v50, s[48:51], s59 offen lds
    s_add_u32 m0, s60, 3072
    s_add_u32 s59, s59, 44032
    buffer_load_dwordx4 v48, s[48:51], s59 offen lds
    s_add_u32 m0, s60, 4096
    s_nop 0
    buffer_load_dwordx4 v49, s[48:51], s59 offen lds
    s_add_u32 m0, s60, 5120
    s_nop 0
    buffer_load_dwordx4 v50, s[48:51], s59 offen lds
    s_cmp_lg_u32 s73, 147456
    s_cselect_b32 s73, s73, 0
    v_add_u32 v13, 1, v13
    s_add_u32 s74, s74, 1
    v_max_u32 v15, v13, v14
    s_waitcnt vmcnt(6)
    ds_write_b32 v7, v15
    s_cmp_lg_u32 s74, 20
    s_cbranch_scc1 L_ring_gu
L_ring_w0:
    s_mov_b32 s63, 2097152
L_lw_151:
    ds_read_b32 v12, v4 offset:0
    s_sub_u32 s63, s63, 1
    s_cbranch_scc1 L_lwd_152
    s_waitcnt lgkmcnt(0)
    v_cmp_gt_u32 vcc, s74, v12
    s_nop 0
    s_cbranch_vccz L_lwd_152
    s_sleep 2
    s_branch L_lw_151
L_lwd_152:
    s_add_u32 s60, s73, s69
    s_add_u32 m0, s60, 0
    s_add_u32 s59, s70, 32768
    buffer_load_dwordx4 v51, s[40:43], s70 offen lds
    s_add_u32 m0, s60, 2048
    s_cmp_lg_u32 s59, 1376256
    buffer_load_dwordx4 v47, s[40:43], s70 offen lds
    s_cselect_b32 s70, s59, 0
    s_add_u32 m0, s60, 4096
    s_add_u32 s59, s70, 32768
    buffer_load_dwordx4 v51, s[40:43], s70 offen lds
    s_add_u32 m0, s60, 6144
    s_cmp_lg_u32 s59, 1376256
    buffer_load_dwordx4 v47, s[40:43], s70 offen lds
    s_cselect_b32 s70, s59, 0
    s_add_u32 m0, s60, 8192
    s_add_u32 s59, s70, 32768
    buffer_load_dwordx4 v51, s[40:43], s70 offen lds
    s_add_u32 m0, s60, 10240
    s_cmp_lg_u32 s59, 1376256
    buffer_load_dwordx4 v47, s[40:43], s70 offen lds
    s_cselect_b32 s70, s59, 0
    s_add_u32 s73, s73, 12288
    s_cmp_lg_u32 s73, 147456
    s_cselect_b32 s73, s73, 0
    v_add_u32 v13, 1, v13
    s_add_u32 s74, s74, 1
    v_max_u32 v15, v13, v14
    s_waitcnt vmcnt(6)
    ds_write_b32 v7, v15
    s_cmp_lg_u32 s74, 21
    s_cbranch_scc1 L_ring_w0
    v_mov_b32 v14, v15
    v_subrev_u32 v13, 2, v13
L_ring_wd:
    s_mov_b32 s63, 2097152
L_lw_153:
    ds_read_b32 v12, v4 offset:0
    s_sub_u32 s63, s63, 1
    s_cbranch_scc1 L_lwd_154
    s_waitcnt lgkmcnt(0)
    v_cmp_gt_u32 vcc, s74, v12
    s_nop 0
    s_cbranch_vccz L_lwd_154
    s_sleep 2
    s_branch L_lw_153
L_lwd_154:
    s_add_u32 s60, s73, s69
    s_add_u32 m0, s60, 0
    s_add_u32 s59, s70, 32768
    buffer_load_dwordx4 v51, s[40:43], s70 offen lds
    s_add_u32 m0, s60, 2048
    s_cmp_lg_u32 s59, 1376256
    buffer_load_dwordx4 v47, s[40:43], s70 offen lds
    s_cselect_b32 s70, s59, 0
    s_add_u32 m0, s60, 4096
    s_add_u32 s59, s70, 32768
    buffer_load_dwordx4 v51, s[40:43], s70 offen lds
    s_add_u32 m0, s60, 6144
    s_cmp_lg_u32 s59, 1376256
    buffer_load_dwordx4 v47, s[40:43], s70 offen lds
    s_cselect_b32 s70, s59, 0
    s_add_u32 m0, s60, 8192
    s_add_u32 s59, s70, 32768
    buffer_load_dwordx4 v51, s[40:43], s70 offen lds
    s_add_u32 m0, s60, 10240
    s_cmp_lg_u32 s59, 1376256
    buffer_load_dwordx4 v47, s[40:43], s70 offen lds
    s_cselect_b32 s70, s59, 0
    s_add_u32 s73, s73, 12288
    s_cmp_lg_u32 s73, 147456
    s_cselect_b32 s73, s73, 0
    v_add_u32 v13, 1, v13
    s_add_u32 s74, s74, 1
    v_max_u32 v15, v13, v14
    s_waitcnt vmcnt(18)
    ds_write_b32 v7, v15
    s_cmp_lg_u32 s74, 32
    s_cbranch_scc1 L_ring_wd
    s_add_u32 s59, s70, 32768
    buffer_load_dwordx4 v[64:67], v51, s[40:43], s70 offen
    s_cmp_lg_u32 s59, 1376256
    buffer_load_dwordx4 v[68:71], v47, s[40:43], s70 offen
    s_cselect_b32 s70, s59, 0
    s_add_u32 s59, s70, 32768
    buffer_load_dwordx4 v[72:75], v51, s[40:43], s70 offen
    s_cmp_lg_u32 s59, 1376256
    buffer_load_dwordx4 v[76:79], v47, s[40:43], s70 offen
    s_cselect_b32 s70, s59, 0
    s_add_u32 s59, s70, 32768
    buffer_load_dwordx4 v[80:83], v51, s[40:43], s70 offen
    s_cmp_lg_u32 s59, 1376256
    buffer_load_dwordx4 v[84:87], v47, s[40:43], s70 offen
    s_cselect_b32 s70, s59, 0
    s_add_u32 s59, s70, 32768
    buffer_load_dwordx4 v[88:91], v51, s[40:43], s70 offen
    s_cmp_lg_u32 s59, 1376256
    buffer_load_dwordx4 v[92:95], v47, s[40:43], s70 offen
    s_cselect_b32 s70, s59, 0
    s_add_u32 s59, s70, 32768
    buffer_load_dwordx4 v[96:99], v51, s[40:43], s70 offen
    s_cmp_lg_u32 s59, 1376256
    buffer_load_dwordx4 v[100:103], v47, s[40:43], s70 offen
    s_cselect_b32 s70, s59, 0
    s_add_u32 s59, s70, 32768
    buffer_load_dwordx4 v[104:107], v51, s[40:43], s70 offen
    s_cmp_lg_u32 s59, 1376256
    buffer_load_dwordx4 v[108:111], v47, s[40:43], s70 offen
    s_cselect_b32 s70, s59, 0
    s_mov_b32 s70, 1376256
    s_add_u32 s59, s70, 32768
    buffer_load_dwordx4 v[112:115], v51, s[40:43], s70 offen
    s_cmp_lg_u32 s59, 1376256
    buffer_load_dwordx4 v[116:119], v47, s[40:43], s70 offen
    s_cselect_b32 s70, s59, 0
    v_add_u32 v13, 1, v13
    s_waitcnt vmcnt(26)
    ds_write_b32 v7, v13
    v_add_u32 v13, 1, v13
    s_waitcnt vmcnt(20)
    ds_write_b32 v7, v13
    v_add_u32 v13, 1, v13
    s_waitcnt vmcnt(14)
    ds_write_b32 v7, v13
    v_add_u32 v16, s69, v1
    s_mov_b32 s63, 2097152
L_lw_155:
    ds_read_b32 v12, v4 offset:0
    s_sub_u32 s63, s63, 1
    s_cbranch_scc1 L_lwd_156
    s_waitcnt lgkmcnt(0)
    v_cmp_gt_u32 vcc, 32, v12
    s_nop 0
    s_cbranch_vccz L_lwd_156
    s_sleep 1
    s_branch L_lw_155
L_lwd_156:
    s_waitcnt vmcnt(8)
    ds_write_b128 v16, v[64:67] offset:0
    ds_write_b128 v16, v[68:71] offset:2048
    ds_write_b128 v16, v[72:75] offset:4096
    ds_write_b128 v16, v[76:79] offset:6144
    ds_write_b128 v16, v[80:83] offset:8192
    ds_write_b128 v16, v[84:87] offset:10240
    v_mov_b32 v13, 44
    ds_write_b32 v7, v13
    s_mov_b32 s63, 2097152
L_lw_157:
    ds_read_b32 v12, v4 offset:0
    s_sub_u32 s63, s63, 1
    s_cbranch_scc1 L_lwd_158
    s_waitcnt lgkmcnt(0)
    v_cmp_gt_u32 vcc, 33, v12
    s_nop 0
    s_cbranch_vccz L_lwd_158
    s_sleep 1
    s_branch L_lw_157
L_lwd_158:
    s_waitcnt vmcnt(2)
    ds_write_b128 v16, v[88:91] offset:12288
    ds_write_b128 v16, v[92:95] offset:14336
    ds_write_b128 v16, v[96:99] offset:16384
    ds_write_b128 v16, v[100:103] offset:18432
    ds_write_b128 v16, v[104:107] offset:20480
    ds_write_b128 v16, v[108:111] offset:22528
    v_mov_b32 v13, 45
    ds_write_b32 v7, v13
    s_mov_b32 s63, 2097152
L_lw_159:
    ds_read_b32 v12, v4 offset:0
    s_sub_u32 s63, s63, 1
    s_cbranch_scc1 L_lwd_160
    s_waitcnt lgkmcnt(0)
    v_cmp_gt_u32 vcc, 34, v12
    s_nop 0
    s_cbranch_vccz L_lwd_160
    s_sleep 1
    s_branch L_lw_159
L_lwd_160:
    s_waitcnt vmcnt(0)
    ds_write_b128 v16, v[112:115] offset:24576
    ds_write_b128 v16, v[116:119] offset:26624
    v_mov_b32 v13, 46
    ds_write_b32 v7, v13
    s_waitcnt lgkmcnt(0)
    s_branch L_fin
L_pw:
    s_waitcnt lgkmcnt(0)
    s_and_b32 s24, s53, 1
    s_and_b32 s25, s2, 7
    s_lshl1_add_u32 s6, s2, s24
    s_mul_i32 s6, s6, 3072
    s_mov_b32 s27, 0
    s_mov_b32 s26, 1
L_pw_161:
    s_sub_u32 s59, s27, 64
    s_cselect_b32 s27, s27, s59
    s_mul_i32 s59, s27, 0
    s_add_u32 s59, s59, s6
    s_add_u32 s4, s8, s59
    s_addc_u32 s5, s9, 0
    s_load_dword s44, s[4:5], 0
    s_load_dword s45, s[4:5], 64
    s_load_dword s46, s[4:5], 128
    s_load_dword s47, s[4:5], 192
    s_load_dword s44, s[4:5], 256
    s_load_dword s45, s[4:5], 320
    s_load_dword s46, s[4:5], 384
    s_load_dword s47, s[4:5], 448
    s_load_dword s44, s[4:5], 512
    s_load_dword s45, s[4:5], 576
    s_load_dword s46, s[4:5], 640
    s_load_dword s47, s[4:5], 704
    s_load_dword s44, s[4:5], 768
    s_load_dword s45, s[4:5], 832
    s_load_dword s46, s[4:5], 896
    s_load_dword s47, s[4:5], 960
    s_waitcnt vmcnt(0)
    v_mov_b32 v12, 0x100
    ds_write2_b32 v7, v12, v12 offset0:0 offset1:8
    s_add_u32 s27, s27, 1
    s_sub_u32 s26, s26, 1
    s_cmp_lg_u32 s26, 0
    s_cbranch_scc1 L_pw_161
    s_lshl1_add_u32 s6, s2, s24
    s_mul_i32 s6, s6, 1024
    s_mov_b32 s27, 0
    s_mov_b32 s26, 1
L_pw_162:
    s_sub_u32 s59, s27, 64
    s_cselect_b32 s27, s27, s59
    s_mul_i32 s59, s27, 0
    s_add_u32 s59, s59, s6
    s_add_u32 s4, s28, s59
    s_addc_u32 s5, s29, 0
    s_load_dword s44, s[4:5], 0
    s_load_dword s45, s[4:5], 64
    s_load_dword s46, s[4:5], 128
    s_load_dword s47, s[4:5], 192
    s_load_dword s44, s[4:5], 256
    s_load_dword s45, s[4:5], 320
    s_load_dword s46, s[4:5], 384
    s_load_dword s47, s[4:5], 448
    s_load_dword s44, s[4:5], 512
    s_load_dword s45, s[4:5], 576
    s_load_dword s46, s[4:5], 640
    s_load_dword s47, s[4:5], 704
    s_load_dword s44, s[4:5], 768
    s_load_dword s45, s[4:5], 832
    s_load_dword s46, s[4:5], 896
    s_load_dword s47, s[4:5], 960
    s_add_u32 s27, s27, 1
    s_sub_u32 s26, s26, 1
    s_cmp_lg_u32 s26, 0
    s_cbranch_scc1 L_pw_162
    s_lshl1_add_u32 s6, s2, s24
    s_mul_i32 s6, s6, 2752
    s_mov_b32 s27, 0
    s_mov_b32 s26, 1
L_pw_163:
    s_sub_u32 s59, s27, 64
    s_cselect_b32 s27, s27, s59
    s_mul_i32 s59, s27, 0
    s_add_u32 s59, s59, s6
    s_add_u32 s4, s32, s59
    s_addc_u32 s5, s33, 0
    s_load_dword s44, s[4:5], 0
    s_load_dword s45, s[4:5], 64
    s_load_dword s46, s[4:5], 128
    s_load_dword s47, s[4:5], 192
    s_load_dword s44, s[4:5], 256
    s_load_dword s45, s[4:5], 320
    s_load_dword s46, s[4:5], 384
    s_load_dword s47, s[4:5], 448
    s_load_dword s44, s[4:5], 512
    s_load_dword s45, s[4:5], 576
    s_load_dword s46, s[4:5], 640
    s_load_dword s47, s[4:5], 704
    s_load_dword s44, s[4:5], 768
    s_load_dword s45, s[4:5], 832
    s_load_dword s46, s[4:5], 896
    s_load_dword s47, s[4:5], 960
    s_load_dword s44, s[4:5], 1024
    s_load_dword s45, s[4:5], 1088
    s_load_dword s46, s[4:5], 1152
    s_load_dword s47, s[4:5], 1216
    s_load_dword s44, s[4:5], 1280
    s_load_dword s45, s[4:5], 1344
    s_load_dword s46, s[4:5], 1408
    s_load_dword s47, s[4:5], 1472
    s_load_dword s44, s[4:5], 1536
    s_load_dword s45, s[4:5], 1600
    s_load_dword s46, s[4:5], 1664
    s_load_dword s47, s[4:5], 1728
    s_load_dword s44, s[4:5], 1792
    s_load_dword s45, s[4:5], 1856
    s_load_dword s46, s[4:5], 1920
    s_load_dword s47, s[4:5], 1984
    s_load_dword s44, s[4:5], 2048
    s_load_dword s45, s[4:5], 2112
    s_load_dword s46, s[4:5], 2176
    s_load_dword s47, s[4:5], 2240
    s_load_dword s44, s[4:5], 2304
    s_load_dword s45, s[4:5], 2368
    s_load_dword s46, s[4:5], 2432
    s_load_dword s47, s[4:5], 2496
    s_load_dword s44, s[4:5], 2560
    s_load_dword s45, s[4:5], 2624
    s_load_dword s46, s[4:5], 2688
    s_add_u32 s27, s27, 1
    s_sub_u32 s26, s26, 1
    s_cmp_lg_u32 s26, 0
    s_cbranch_scc1 L_pw_163
    s_lshl1_add_u32 s6, s2, s24
    s_mul_i32 s6, s6, 2752
    s_mov_b32 s27, 0
    s_mov_b32 s26, 1
L_pw_164:
    s_sub_u32 s59, s27, 64
    s_cselect_b32 s27, s27, s59
    s_mul_i32 s59, s27, 0
    s_add_u32 s59, s59, s6
    s_add_u32 s4, s36, s59
    s_addc_u32 s5, s37, 0
    s_load_dword s44, s[4:5], 0
    s_load_dword s45, s[4:5], 64
    s_load_dword s46, s[4:5], 128
    s_load_dword s47, s[4:5], 192
    s_load_dword s44, s[4:5], 256
    s_load_dword s45, s[4:5], 320
    s_load_dword s46, s[4:5], 384
    s_load_dword s47, s[4:5], 448
    s_load_dword s44, s[4:5], 512
    s_load_dword s45, s[4:5], 576
    s_load_dword s46, s[4:5], 640
    s_load_dword s47, s[4:5], 704
    s_load_dword s44, s[4:5], 768
    s_load_dword s45, s[4:5], 832
    s_load_dword s46, s[4:5], 896
    s_load_dword s47, s[4:5], 960
    s_load_dword s44, s[4:5], 1024
    s_load_dword s45, s[4:5], 1088
    s_load_dword s46, s[4:5], 1152
    s_load_dword s47, s[4:5], 1216
    s_load_dword s44, s[4:5], 1280
    s_load_dword s45, s[4:5], 1344
    s_load_dword s46, s[4:5], 1408
    s_load_dword s47, s[4:5], 1472
    s_load_dword s44, s[4:5], 1536
    s_load_dword s45, s[4:5], 1600
    s_load_dword s46, s[4:5], 1664
    s_load_dword s47, s[4:5], 1728
    s_load_dword s44, s[4:5], 1792
    s_load_dword s45, s[4:5], 1856
    s_load_dword s46, s[4:5], 1920
    s_load_dword s47, s[4:5], 1984
    s_load_dword s44, s[4:5], 2048
    s_load_dword s45, s[4:5], 2112
    s_load_dword s46, s[4:5], 2176
    s_load_dword s47, s[4:5], 2240
    s_load_dword s44, s[4:5], 2304
    s_load_dword s45, s[4:5], 2368
    s_load_dword s46, s[4:5], 2432
    s_load_dword s47, s[4:5], 2496
    s_load_dword s44, s[4:5], 2560
    s_load_dword s45, s[4:5], 2624
    s_load_dword s46, s[4:5], 2688
    s_add_u32 s27, s27, 1
    s_sub_u32 s26, s26, 1
    s_cmp_lg_u32 s26, 0
    s_cbranch_scc1 L_pw_164
    s_lshl4_add_u32 s6, s24, s55
    s_lshl_b32 s6, s6, 10
    s_add_u32 s6, s6, s57
    s_add_u32 s6, s6, 0x8000
    s_mov_b32 s27, 0
    s_mov_b32 s26, 4
L_pw_165:
    s_sub_u32 s59, s27, 64
    s_cselect_b32 s27, s27, s59
    s_mul_i32 s59, s27, 131072
    s_add_u32 s59, s59, s6
    s_add_u32 s4, s12, s59
    s_addc_u32 s5, s13, 0
    s_load_dword s44, s[4:5], 0
    s_load_dword s45, s[4:5], 64
    s_load_dword s46, s[4:5], 128
    s_load_dword s47, s[4:5], 192
    s_load_dword s44, s[4:5], 256
    s_load_dword s45, s[4:5], 320
    s_load_dword s46, s[4:5], 384
    s_load_dword s47, s[4:5], 448
    s_load_dword s44, s[4:5], 512
    s_load_dword s45, s[4:5], 576
    s_load_dword s46, s[4:5], 640
    s_load_dword s47, s[4:5], 704
    s_load_dword s44, s[4:5], 768
    s_load_dword s45, s[4:5], 832
    s_load_dword s46, s[4:5], 896
    s_load_dword s47, s[4:5], 960
    s_add_u32 s27, s27, 1
    s_sub_u32 s26, s26, 1
    s_cmp_lg_u32 s26, 0
    s_cbranch_scc1 L_pw_165
    s_lshl1_add_u32 s6, s55, s24
    s_lshl_b32 s6, s6, 9
    s_add_u32 s6, s6, s57
    s_add_u32 s6, s6, 0x81000
    s_mov_b32 s27, 0
    s_mov_b32 s26, 1
L_pw_166:
    s_sub_u32 s59, s27, 64
    s_cselect_b32 s27, s27, s59
    s_mul_i32 s59, s27, 0
    s_add_u32 s59, s59, s6
    s_add_u32 s4, s12, s59
    s_addc_u32 s5, s13, 0
    s_load_dword s44, s[4:5], 0
    s_load_dword s45, s[4:5], 64
    s_load_dword s46, s[4:5], 128
    s_load_dword s47, s[4:5], 192
    s_load_dword s44, s[4:5], 256
    s_load_dword s45, s[4:5], 320
    s_load_dword s46, s[4:5], 384
    s_load_dword s47, s[4:5], 448
    s_add_u32 s27, s27, 1
    s_sub_u32 s26, s26, 1
    s_cmp_lg_u32 s26, 0
    s_cbranch_scc1 L_pw_166
    s_lshl1_add_u32 s6, s2, s24
    s_mul_i32 s6, s6, 2752
    s_mov_b32 s27, 0
    s_mov_b32 s26, 1
L_pw_167:
    s_sub_u32 s59, s27, 64
    s_cselect_b32 s27, s27, s59
    s_mul_i32 s59, s27, 0
    s_add_u32 s59, s59, s6
    s_add_u32 s4, s40, s59
    s_addc_u32 s5, s41, 0
    s_load_dword s44, s[4:5], 0
    s_load_dword s45, s[4:5], 64
    s_load_dword s46, s[4:5], 128
    s_load_dword s47, s[4:5], 192
    s_load_dword s44, s[4:5], 256
    s_load_dword s45, s[4:5], 320
    s_load_dword s46, s[4:5], 384
    s_load_dword s47, s[4:5], 448
    s_load_dword s44, s[4:5], 512
    s_load_dword s45, s[4:5], 576
    s_load_dword s46, s[4:5], 640
    s_load_dword s47, s[4:5], 704
    s_load_dword s44, s[4:5], 768
    s_load_dword s45, s[4:5], 832
    s_load_dword s46, s[4:5], 896
    s_load_dword s47, s[4:5], 960
    s_load_dword s44, s[4:5], 1024
    s_load_dword s45, s[4:5], 1088
    s_load_dword s46, s[4:5], 1152
    s_load_dword s47, s[4:5], 1216
    s_load_dword s44, s[4:5], 1280
    s_load_dword s45, s[4:5], 1344
    s_load_dword s46, s[4:5], 1408
    s_load_dword s47, s[4:5], 1472
    s_load_dword s44, s[4:5], 1536
    s_load_dword s45, s[4:5], 1600
    s_load_dword s46, s[4:5], 1664
    s_load_dword s47, s[4:5], 1728
    s_load_dword s44, s[4:5], 1792
    s_load_dword s45, s[4:5], 1856
    s_load_dword s46, s[4:5], 1920
    s_load_dword s47, s[4:5], 1984
    s_load_dword s44, s[4:5], 2048
    s_load_dword s45, s[4:5], 2112
    s_load_dword s46, s[4:5], 2176
    s_load_dword s47, s[4:5], 2240
    s_load_dword s44, s[4:5], 2304
    s_load_dword s45, s[4:5], 2368
    s_load_dword s46, s[4:5], 2432
    s_load_dword s47, s[4:5], 2496
    s_load_dword s44, s[4:5], 2560
    s_load_dword s45, s[4:5], 2624
    s_load_dword s46, s[4:5], 2688
    s_add_u32 s27, s27, 1
    s_sub_u32 s26, s26, 1
    s_cmp_lg_u32 s26, 0
    s_cbranch_scc1 L_pw_167
    s_waitcnt lgkmcnt(0)
    s_branch L_fin
L_fin:
L_end:
    s_endpgm
L_slow_7:
    buffer_store_dwordx4 v[32:35], v93, s[12:15], s68 offen sc1
    buffer_store_dwordx4 v[36:39], v93, s[12:15], s68 offen offset:2048 sc1
    s_branch L_sd_8
L_slow_9:
    s_waitcnt vmcnt(0)
    buffer_store_dword v127, v6, s[12:15], s69 offen sc1
    s_branch L_sd_10
L_slow_19:
    buffer_store_dwordx4 v[56:59], v1, s[12:15], s66 offen sc1
    buffer_store_dwordx4 v[60:63], v1, s[12:15], s67 offen sc1
    s_branch L_sd_20
L_slow_21:
    s_waitcnt vmcnt(0)
    buffer_store_dword v127, v6, s[12:15], s68 offen sc1
    s_branch L_sd_22
L_cks_27:
    s_mov_b32 s63, 2097152
L_lw_29:
    ds_read_b32 v24, v4 offset:48
    s_sub_u32 s63, s63, 1
    s_cbranch_scc1 L_lwd_30
    s_waitcnt lgkmcnt(0)
    v_cmp_gt_u32 vcc, 1, v24
    s_nop 0
    s_cbranch_vccnz L_lw_29
L_lwd_30:
    s_branch L_ck_28
L_slow_31:
    buffer_store_dwordx4 v[24:27], v1, s[12:15], s73 offen sc1
    s_branch L_sd_32
L_slow_33:
    buffer_store_dwordx4 v[32:35], v1, s[12:15], s71 offen sc1
    buffer_store_dwordx4 v[36:39], v1, s[12:15], s71 offen offset:1024 sc1
    s_branch L_sd_34
L_slow_35:
    s_waitcnt vmcnt(0)
    buffer_store_dword v127, v6, s[12:15], s74 offen sc1
    s_branch L_sd_36
L_cks_39:
    s_mov_b32 s63, 2097152
L_lw_41:
    ds_read_b32 v5, v4 offset:16
    s_sub_u32 s63, s63, 1
    s_cbranch_scc1 L_lwd_42
    s_waitcnt lgkmcnt(0)
    v_cmp_gt_u32 vcc, 17, v5
    s_nop 0
    s_cbranch_vccnz L_lw_41
L_lwd_42:
    s_branch L_ck_40
L_cks_43:
    s_mov_b32 s63, 2097152
L_lw_45:
    ds_read_b32 v5, v4 offset:16
    s_sub_u32 s63, s63, 1
    s_cbranch_scc1 L_lwd_46
    s_waitcnt lgkmcnt(0)
    v_cmp_gt_u32 vcc, 18, v5
    s_nop 0
    s_cbranch_vccnz L_lw_45
L_lwd_46:
    s_branch L_ck_44
L_cks_47:
    s_mov_b32 s63, 2097152
L_lw_49:
    ds_read_b32 v5, v4 offset:16
    s_sub_u32 s63, s63, 1
    s_cbranch_scc1 L_lwd_50
    s_waitcnt lgkmcnt(0)
    v_cmp_gt_u32 vcc, 19, v5
    s_nop 0
    s_cbranch_vccnz L_lw_49
L_lwd_50:
    s_branch L_ck_48
L_cks_51:
    s_mov_b32 s63, 2097152
L_lw_53:
    ds_read_b32 v5, v4 offset:16
    s_sub_u32 s63, s63, 1
    s_cbranch_scc1 L_lwd_54
    s_waitcnt lgkmcnt(0)
    v_cmp_gt_u32 vcc, 20, v5
    s_nop 0
    s_cbranch_vccnz L_lw_53
L_lwd_54:
    s_branch L_ck_52
L_cks_55:
    s_mov_b32 s63, 2097152
L_lw_57:
    ds_read_b32 v5, v4 offset:16
    s_sub_u32 s63, s63, 1
    s_cbranch_scc1 L_lwd_58
    s_waitcnt lgkmcnt(0)
    v_cmp_gt_u32 vcc, 21, v5
    s_nop 0
    s_cbranch_vccnz L_lw_57
L_lwd_58:
    s_branch L_ck_56
L_cks_59:
    s_mov_b32 s63, 2097152
L_lw_61:
    ds_read_b32 v5, v4 offset:16
    s_sub_u32 s63, s63, 1
    s_cbranch_scc1 L_lwd_62
    s_waitcnt lgkmcnt(0)
    v_cmp_gt_u32 vcc, 22, v5
    s_nop 0
    s_cbranch_vccnz L_lw_61
L_lwd_62:
    s_branch L_ck_60
L_cks_63:
    s_mov_b32 s63, 2097152
L_lw_65:
    ds_read_b32 v5, v4 offset:16
    s_sub_u32 s63, s63, 1
    s_cbranch_scc1 L_lwd_66
    s_waitcnt lgkmcnt(0)
    v_cmp_gt_u32 vcc, 23, v5
    s_nop 0
    s_cbranch_vccnz L_lw_65
L_lwd_66:
    s_branch L_ck_64
L_cks_67:
    s_mov_b32 s63, 2097152
L_lw_69:
    ds_read_b32 v5, v4 offset:16
    s_sub_u32 s63, s63, 1
    s_cbranch_scc1 L_lwd_70
    s_waitcnt lgkmcnt(0)
    v_cmp_gt_u32 vcc, 24, v5
    s_nop 0
    s_cbranch_vccnz L_lw_69
L_lwd_70:
    s_branch L_ck_68
L_cks_71:
    s_mov_b32 s63, 2097152
L_lw_73:
    ds_read_b32 v5, v4 offset:16
    s_sub_u32 s63, s63, 1
    s_cbranch_scc1 L_lwd_74
    s_waitcnt lgkmcnt(0)
    v_cmp_gt_u32 vcc, 25, v5
    s_nop 0
    s_cbranch_vccnz L_lw_73
L_lwd_74:
    s_branch L_ck_72
L_cks_75:
    s_mov_b32 s63, 2097152
L_lw_77:
    ds_read_b32 v5, v4 offset:16
    s_sub_u32 s63, s63, 1
    s_cbranch_scc1 L_lwd_78
    s_waitcnt lgkmcnt(0)
    v_cmp_gt_u32 vcc, 26, v5
    s_nop 0
    s_cbranch_vccnz L_lw_77
L_lwd_78:
    s_branch L_ck_76
L_cks_79:
    s_mov_b32 s63, 2097152
L_lw_81:
    ds_read_b32 v5, v4 offset:16
    s_sub_u32 s63, s63, 1
    s_cbranch_scc1 L_lwd_82
    s_waitcnt lgkmcnt(0)
    v_cmp_gt_u32 vcc, 27, v5
    s_nop 0
    s_cbranch_vccnz L_lw_81
L_lwd_82:
    s_branch L_ck_80
L_cks_83:
    s_mov_b32 s63, 2097152
L_lw_85:
    ds_read_b32 v5, v4 offset:16
    s_sub_u32 s63, s63, 1
    s_cbranch_scc1 L_lwd_86
    s_waitcnt lgkmcnt(0)
    v_cmp_gt_u32 vcc, 28, v5
    s_nop 0
    s_cbranch_vccnz L_lw_85
L_lwd_86:
    s_branch L_ck_84
L_cks_87:
    s_mov_b32 s63, 2097152
L_lw_89:
    ds_read_b32 v5, v4 offset:16
    s_sub_u32 s63, s63, 1
    s_cbranch_scc1 L_lwd_90
    s_waitcnt lgkmcnt(0)
    v_cmp_gt_u32 vcc, 31, v5
    s_nop 0
    s_cbranch_vccnz L_lw_89
L_lwd_90:
    s_branch L_ck_88
L_slow_91:
    s_waitcnt vmcnt(0)
    buffer_store_dword v5, v6, s[12:15], s76 offen sc1
    s_branch L_sd_92
L_cks_99:
    s_mov_b32 s63, 2097152
L_lw_101:
    ds_read_b32 v24, v4 offset:16
    s_sub_u32 s63, s63, 1
    s_cbranch_scc1 L_lwd_102
    s_waitcnt lgkmcnt(0)
    v_cmp_gt_u32 vcc, 35, v24
    s_nop 0
    s_cbranch_vccnz L_lw_101
L_lwd_102:
    s_branch L_ck_100
L_cks_103:
    s_mov_b32 s63, 2097152
L_lw_105:
    ds_read_b32 v24, v4 offset:16
    s_sub_u32 s63, s63, 1
    s_cbranch_scc1 L_lwd_106
    s_waitcnt lgkmcnt(0)
    v_cmp_gt_u32 vcc, 37, v24
    s_nop 0
    s_cbranch_vccnz L_lw_105
L_lwd_106:
    s_branch L_ck_104
L_cks_107:
    s_mov_b32 s63, 2097152
L_lw_109:
    ds_read_b32 v24, v4 offset:16
    s_sub_u32 s63, s63, 1
    s_cbranch_scc1 L_lwd_110
    s_waitcnt lgkmcnt(0)
    v_cmp_gt_u32 vcc, 39, v24
    s_nop 0
    s_cbranch_vccnz L_lw_109
L_lwd_110:
    s_branch L_ck_108
L_cks_111:
    s_mov_b32 s63, 2097152
L_lw_113:
    ds_read_b32 v24, v4 offset:16
    s_sub_u32 s63, s63, 1
    s_cbranch_scc1 L_lwd_114
    s_waitcnt lgkmcnt(0)
    v_cmp_gt_u32 vcc, 41, v24
    s_nop 0
    s_cbranch_vccnz L_lw_113
L_lwd_114:
    s_branch L_ck_112
L_cks_115:
    s_mov_b32 s63, 2097152
L_lw_117:
    ds_read_b32 v24, v4 offset:16
    s_sub_u32 s63, s63, 1
    s_cbranch_scc1 L_lwd_118
    s_waitcnt lgkmcnt(0)
    v_cmp_gt_u32 vcc, 43, v24
    s_nop 0
    s_cbranch_vccnz L_lw_117
L_lwd_118:
    s_branch L_ck_116
L_cks_119:
    s_mov_b32 s63, 2097152
L_lw_121:
    ds_read_b32 v24, v4 offset:16
    s_sub_u32 s63, s63, 1
    s_cbranch_scc1 L_lwd_122
    s_waitcnt lgkmcnt(0)
    v_cmp_gt_u32 vcc, 45, v24
    s_nop 0
    s_cbranch_vccnz L_lw_121
L_lwd_122:
    s_branch L_ck_120
L_cks_123:
    s_mov_b32 s63, 2097152
L_lw_125:
    ds_read_b32 v24, v4 offset:16
    s_sub_u32 s63, s63, 1
    s_cbranch_scc1 L_lwd_126
    s_waitcnt lgkmcnt(0)
    v_cmp_gt_u32 vcc, 46, v24
    s_nop 0
    s_cbranch_vccnz L_lw_125
L_lwd_126:
    s_branch L_ck_124
.section .rodata,"a"
.p2align 6
.amdhsa_kernel adaLN_cond__linear_kernel_hedgehog__glu_gated_reglu__prompt_kernel
  .amdhsa_next_free_vgpr 256
  .amdhsa_next_free_sgpr 102
  .amdhsa_accum_offset 128
  .amdhsa_group_segment_fixed_size 0
  .amdhsa_kernarg_size 104
  .amdhsa_user_sgpr_count 2
  .amdhsa_user_sgpr_kernarg_segment_ptr 1
  .amdhsa_system_sgpr_workgroup_id_x 1
.end_amdhsa_kernel
```
